```python
import torch

def _softmax(x, axis=-1):
    return torch.softmax(x, dim=axis)
def _gelu(x):
    return torch.nn.functional.gelu(x, approximate="tanh")
def _silu(x):
    return torch.nn.functional.silu(x)
def _sigmoid(x):
    return torch.sigmoid(x)
def _layernorm(x, axis=-1, eps=1e-5):
    m = x.mean(dim=axis, keepdim=True)
    v = x.var(dim=axis, keepdim=True, unbiased=False)
    return (x - m) / torch.sqrt(v + eps)
def _scatter_add(tgt, idx, src, axis=0):
    return tgt.clone().index_add_(axis, idx, src)
def _segment_sum(src, seg, n):
    out = torch.zeros((n,) + src.shape[1:], dtype=src.dtype)
    return out.index_add_(0, seg, src)
def _pad(x, pw):
    flat = tuple(v for pair in reversed(pw) for v in pair)
    return torch.nn.functional.pad(x, flat)

kernel_name = 'standalone__linear_attn_block__prompt'

def setup_inputs():

    _w = (lambda a: (lambda t: t.to(torch.bfloat16) if t.is_floating_point() else t)(torch.as_tensor(a)))
    B, S, D = 1, 2048, 576
    return {
        "x": _w((lambda *s: torch.randn(*s, dtype=torch.bfloat16) * 0.05)(B, S, D)),
        "wqkv": _w((lambda *s: torch.randn(*s, dtype=torch.bfloat16) * 0.4)(D, 3 * D)),
        "wo": _w((lambda *s: torch.randn(*s, dtype=torch.bfloat16) * 0.05)(D, D)),
    }

def reference(x, wqkv, wo):
    B, S, D = x.shape
    H = 32; Dh = D // H
    qkv = (lambda x, *d: x.permute(*d))((x @ wqkv).reshape(B, S, 3, H, Dh), 2, 0, 3, 1, 4)
    q, k, v = qkv[0], qkv[1], qkv[2]
    phi = lambda t: torch.where(t > 0, t + 1, torch.exp(t)) + 1e-6
    pq, pk = phi(q), phi(k)
    kv = torch.einsum("bhsd,bhse->bhde", pk, v)
    z = torch.einsum("bhsd->bhd", pk)
    num = torch.einsum("bhqd,bhde->bhqe", pq, kv)
    den = torch.einsum("bhqd,bhd->bhq", pq, z)[..., None] + 1e-6
    o = num / den
    return (lambda x, *d: x.permute(*d))(o, 0, 2, 1, 3).reshape(B, S, D) @ wo
```

```asm
; @launch grid=(256,1,1) block=(256,1,1) lds=163840
.amdgcn_target "amdgcn-amd-amdhsa--gfx950"
.text
.globl standalone__linear_attn_block__prompt_kernel
.p2align 8
.type standalone__linear_attn_block__prompt_kernel,@function
standalone__linear_attn_block__prompt_kernel:
  s_cmp_ge_u32 s2, 256
  s_cbranch_scc1 standalone__linear_attn_block__prompt_kernel_end
  s_load_dwordx8 s[68:75], s[0:1], 0
  s_load_dwordx4 s[76:79], s[0:1], 32
  v_lshrrev_b32 v2, 6, v0
  v_and_b32 v1, 63, v0
  s_and_b32 s25, s2, 7
  v_readfirstlane_b32 s24, v2
  s_lshr_b32 s26, s2, 3
  s_cmp_lt_u32 s26, 2
  s_cbranch_scc0 standalone__linear_attn_block__prompt_kernel_hc
  s_cmp_eq_u32 s24, 2
  s_cbranch_scc0 standalone__linear_attn_block__prompt_kernel_hc
  s_getpc_b64 s[4:5]
standalone__linear_attn_block__prompt_kernel_pc:
  s_sub_u32 s4, s4, standalone__linear_attn_block__prompt_kernel_pc-standalone__linear_attn_block__prompt_kernel
  s_subb_u32 s5, s5, 0
  v_lshlrev_b32 v2, 7, v1
  global_load_dword v128, v2, s[4:5]
  v_add_u32 v2, 8192, v2
  global_load_dword v129, v2, s[4:5]
  v_add_u32 v2, 8192, v2
  v_cmp_gt_u32 vcc, standalone__linear_attn_block__prompt_kernel_end-standalone__linear_attn_block__prompt_kernel, v2
  s_and_saveexec_b64 s[54:55], vcc
  s_cbranch_execz standalone__linear_attn_block__prompt_kernel_hc2
  global_load_dword v130, v2, s[4:5]
standalone__linear_attn_block__prompt_kernel_hc2:
  s_mov_b64 exec, -1
standalone__linear_attn_block__prompt_kernel_hc:
  s_cmp_lt_u32 s26, 8
  s_cbranch_scc1 standalone__linear_attn_block__prompt_kernel_helper
  s_sub_u32 s32, s26, 8
  s_and_b32 s29, s25, 3
  s_lshl_b32 s29, s29, 2
  s_and_b32 s30, s32, 3
  s_add_u32 s27, s29, s30
  s_mov_b32 s39, 0
  s_lshr_b32 s31, s25, 2
  s_cmp_ge_u32 s32, 16
  s_cselect_b32 s67, 1, 0
  s_cbranch_scc1 standalone__linear_attn_block__prompt_kernel_setq
  s_lshl_b32 s31, s31, 2
  s_lshr_b32 s29, s32, 2
  s_add_u32 s28, s31, s29
  s_mul_i32 s29, s28, 144
  s_and_b32 s29, s29, 0xffffffc0
  s_add_u32 s41, s29, 1152
  s_movk_i32 s42, 960
  s_and_b32 s43, s28, 3
  s_lshl_b32 s43, s43, 1
  s_branch standalone__linear_attn_block__prompt_kernel_setc
standalone__linear_attn_block__prompt_kernel_setq:
  s_lshl_b32 s31, s31, 1
  s_sub_u32 s29, s32, 16
  s_lshr_b32 s29, s29, 2
  s_add_u32 s28, s31, s29
  s_mul_i32 s29, s28, 288
  s_and_b32 s41, s29, 0xffffff80
  s_sub_u32 s43, s29, s41
  s_lshr_b32 s43, s43, 3
  s_mov_b32 s42, 0
standalone__linear_attn_block__prompt_kernel_setc:
  s_lshl_b32 s29, s27, 7
  s_lshl_b32 s30, s24, 5
  s_add_u32 s29, s29, s30
  v_lshrrev_b32 v2, 3, v1
  v_and_b32 v3, 7, v1
  v_xor_b32 v3, v3, v2
  v_add_u32 v2, s29, v2
  v_mul_u32_u24 v2, 1152, v2
  v_lshl_add_u32 v12, v3, 4, v2
  v_add_u32 v13, 8192, v12
  v_add_u32 v14, 16384, v12
  v_add_u32 v15, 24576, v12
  s_lshl_b32 s30, s24, 4
  s_mul_i32 s30, s30, 3456
  s_add_u32 s30, s30, s41
  v_mul_u32_u24 v3, 2731, v1
  v_lshrrev_b32 v3, 16, v3
  v_mul_u32_u24 v4, 24, v3
  v_sub_u32 v4, v1, v4
  v_and_b32 v5, 2, v3
  v_xor_b32 v4, v4, v5
  v_mul_u32_u24 v3, 3456, v3
  v_add_u32 v3, s30, v3
  v_cmp_le_u32 vcc, 12, v4
  v_lshl_add_u32 v16, v4, 4, v3
  v_mov_b32 v5, s42
  v_cndmask_b32 v5, 0, v5, vcc
  v_add_u32 v16, v16, v5
  v_xor_b32 v4, 4, v4
  v_cmp_le_u32 vcc, 12, v4
  v_lshl_add_u32 v19, v4, 4, v3
  v_mov_b32 v5, s42
  v_cndmask_b32 v5, 0, v5, vcc
  v_add_u32 v19, 0x6000, v19
  v_add_u32 v19, v19, v5
  v_add_u32 v2, 64, v1
  v_mul_u32_u24 v3, 2731, v2
  v_lshrrev_b32 v3, 16, v3
  v_mul_u32_u24 v4, 24, v3
  v_sub_u32 v4, v2, v4
  v_and_b32 v5, 2, v3
  v_xor_b32 v4, v4, v5
  v_mul_u32_u24 v3, 3456, v3
  v_add_u32 v3, s30, v3
  v_cmp_le_u32 vcc, 12, v4
  v_lshl_add_u32 v17, v4, 4, v3
  v_mov_b32 v5, s42
  v_cndmask_b32 v5, 0, v5, vcc
  v_add_u32 v17, 0xfffffc00, v17
  v_add_u32 v17, v17, v5
  v_xor_b32 v4, 4, v4
  v_cmp_le_u32 vcc, 12, v4
  v_lshl_add_u32 v20, v4, 4, v3
  v_mov_b32 v5, s42
  v_cndmask_b32 v5, 0, v5, vcc
  v_add_u32 v20, 0x6c00, v20
  v_add_u32 v20, v20, v5
  v_add_u32 v2, 128, v1
  v_mul_u32_u24 v3, 2731, v2
  v_lshrrev_b32 v3, 16, v3
  v_mul_u32_u24 v4, 24, v3
  v_sub_u32 v4, v2, v4
  v_and_b32 v5, 2, v3
  v_xor_b32 v4, v4, v5
  v_mul_u32_u24 v3, 3456, v3
  v_add_u32 v3, s30, v3
  v_cmp_le_u32 vcc, 12, v4
  v_lshl_add_u32 v18, v4, 4, v3
  v_mov_b32 v5, s42
  v_cndmask_b32 v5, 0, v5, vcc
  v_add_u32 v18, 0xfffff800, v18
  v_add_u32 v18, v18, v5
  v_xor_b32 v4, 4, v4
  v_cmp_le_u32 vcc, 12, v4
  v_lshl_add_u32 v21, v4, 4, v3
  v_mov_b32 v5, s42
  v_cndmask_b32 v5, 0, v5, vcc
  v_add_u32 v21, 0x6800, v21
  v_add_u32 v21, v21, v5
  s_lshl_b32 s36, s24, 12
  s_mul_i32 s37, s24, 6144
  s_add_u32 s37, s37, 49152
  s_mov_b32 s10, 2359296
  s_mov_b32 s11, 0x20000
  s_mov_b32 s14, 1990656
  s_mov_b32 s15, 0x20000
  s_waitcnt lgkmcnt(0)
  s_mov_b32 s8, s68
  s_mov_b32 s9, s69
  s_mov_b32 s12, s70
  s_mov_b32 s13, s71
  s_add_u32 m0, s36, 0
  s_mul_i32 s40, s39, 1728
  buffer_load_dwordx4 v12, s[8:11], s39 offen offset:0 lds
  buffer_load_dwordx4 v13, s[8:11], s39 offen offset:1024 lds
  buffer_load_dwordx4 v14, s[8:11], s39 offen offset:2048 lds
  buffer_load_dwordx4 v15, s[8:11], s39 offen offset:3072 lds
  s_add_u32 m0, s37, 0
  s_add_u32 s39, s39, 128
  buffer_load_dwordx4 v16, s[12:15], s40 offen offset:0 lds
  buffer_load_dwordx4 v17, s[12:15], s40 offen offset:1024 lds
  buffer_load_dwordx4 v18, s[12:15], s40 offen offset:2048 lds
  buffer_load_dwordx4 v19, s[12:15], s40 offen offset:3072 lds
  s_add_u32 m0, s37, 4096
  s_nop 0
  buffer_load_dwordx4 v20, s[12:15], s40 offen offset:0 lds
  buffer_load_dwordx4 v21, s[12:15], s40 offen offset:1024 lds
  v_and_b32 v8, 15, v1
  v_lshrrev_b32 v9, 4, v1
  v_bfe_u32 v10, v1, 2, 2
  v_and_b32 v11, 3, v1
  s_lshr_b32 s44, s24, 1
  s_and_b32 s45, s24, 1
  s_cmp_eq_u32 s67, 1
  s_cbranch_scc1 standalone__linear_attn_block__prompt_kernel_uq
  s_mul_i32 s29, s44, 9
  s_add_u32 s29, s29, s43
  s_add_u32 s46, s29, 0
  s_add_u32 s47, s29, 5
  s_add_u32 s48, s29, 24
  s_add_u32 s49, s29, 29
  v_and_b32 v2, 1, v11
  v_mul_u32_u24 v2, 9, v2
  v_lshrrev_b32 v3, 1, v11
  v_mul_u32_u24 v3, 24, v3
  v_add3_u32 v7, v2, v3, 4
  s_branch standalone__linear_attn_block__prompt_kernel_uc
standalone__linear_attn_block__prompt_kernel_uq:
  s_mul_i32 s29, s44, 18
  s_add_u32 s29, s29, s43
  s_add_u32 s46, s29, 0
  s_add_u32 s47, s29, 5
  s_add_u32 s48, s29, 9
  s_add_u32 s49, s29, 14
  v_mul_u32_u24 v7, 9, v11
  v_add_u32 v7, 4, v7
standalone__linear_attn_block__prompt_kernel_uc:
  v_add_u32 v7, s43, v7
  v_lshl_add_u32 v2, v9, 3, v10
  v_mul_u32_u24 v2, 384, v2
  v_add_u32 v2, 49152, v2
  v_lshrrev_b32 v3, 1, v10
  v_lshlrev_b32 v3, 2, v3
  v_and_b32 v4, 1, v9
  v_lshl_or_b32 v3, v4, 3, v3
  v_add_u32 v4, s46, v11
  v_xor_b32 v4, v4, v3
  v_lshl_add_u32 v26, v4, 3, v2
  v_add_u32 v4, s47, v11
  v_xor_b32 v4, v4, v3
  v_lshl_add_u32 v27, v4, 3, v2
  v_add_u32 v4, s48, v11
  v_xor_b32 v4, v4, v3
  v_lshl_add_u32 v28, v4, 3, v2
  v_add_u32 v4, s49, v11
  v_xor_b32 v4, v4, v3
  v_lshl_add_u32 v29, v4, 3, v2
  v_xor_b32 v4, v7, v3
  v_lshl_add_u32 v30, v4, 3, v2
  s_lshl_b32 s29, s45, 6
  v_add_u32 v2, s29, v8
  v_lshlrev_b32 v2, 7, v2
  v_and_b32 v3, 7, v1
  v_xor_b32 v3, v3, v9
  v_lshl_add_u32 v2, v3, 4, v2
  s_lshl_b32 s29, s44, 12
  s_xor_b32 s30, s29, 4096
  v_add_u32 v22, s29, v2
  v_add_u32 v23, s30, v2
  v_xor_b32 v24, 64, v22
  v_xor_b32 v25, 64, v23
  s_barrier
  s_add_u32 m0, s36, 16384
  s_mul_i32 s40, s39, 1728
  buffer_load_dwordx4 v12, s[8:11], s39 offen offset:0 lds
  buffer_load_dwordx4 v13, s[8:11], s39 offen offset:1024 lds
  buffer_load_dwordx4 v14, s[8:11], s39 offen offset:2048 lds
  buffer_load_dwordx4 v15, s[8:11], s39 offen offset:3072 lds
  s_add_u32 m0, s37, 24576
  s_add_u32 s39, s39, 128
  buffer_load_dwordx4 v16, s[12:15], s40 offen offset:0 lds
  buffer_load_dwordx4 v17, s[12:15], s40 offen offset:1024 lds
  buffer_load_dwordx4 v18, s[12:15], s40 offen offset:2048 lds
  buffer_load_dwordx4 v19, s[12:15], s40 offen offset:3072 lds
  s_add_u32 m0, s37, 28672
  s_nop 0
  buffer_load_dwordx4 v20, s[12:15], s40 offen offset:0 lds
  buffer_load_dwordx4 v21, s[12:15], s40 offen offset:1024 lds
  s_mov_b32 s50, 0x3fb8aa3b
  s_mov_b32 s51, 0x3fb8aa3b
  s_mov_b32 s52, 0x358637bd
  s_mov_b32 s53, 0x358637bd
  v_mov_b32 v34, 0xbfb8aa3b
  v_mov_b32 v35, 0xbfb8aa3b
  v_cmp_gt_u32 s[56:57], 8, v8
  v_mov_b32 v2, 1.0
  s_nop 0
  v_cndmask_b32 v220, 0, v2, s[56:57]
  v_mov_b32 v221, v220
  v_mov_b32 v222, v220
  v_mov_b32 v223, v220
  s_mov_b32 s20, s78
  s_mov_b32 s21, s79
  s_mov_b32 s22, 2420736
  s_mov_b32 s23, 0x20000
  s_mov_b32 s80, s72
  s_mov_b32 s81, s73
  s_mov_b32 s82, 663552
  s_mov_b32 s83, 0x20000
  s_mov_b32 s84, s74
  s_mov_b32 s85, s75
  s_mov_b32 s86, 2359296
  s_mov_b32 s87, 0x20000
  s_sub_u32 s29, s26, 8
  s_mul_i32 s30, s29, 43
  s_lshr_b32 s30, s30, 8
  s_mul_i32 s31, s30, 6
  s_sub_u32 s38, s29, s31
  s_lshl_b32 s64, s25, 2
  s_add_u32 s64, s64, s30
  s_and_b32 s34, s24, 1
  s_lshr_b32 s33, s24, 1
  s_mul_i32 s31, s38, 192
  v_mul_u32_u24 v3, 5462, v1
  v_lshrrev_b32 v3, 16, v3
  v_mul_u32_u24 v4, 12, v3
  v_sub_u32 v4, v1, v4
  v_mul_u32_u24 v5, 1152, v3
  v_lshl_add_u32 v250, v4, 4, v5
  v_lshrrev_b32 v6, 1, v3
  v_and_b32 v6, 2, v6
  v_xor_b32 v4, v4, v6
  v_lshl_add_u32 v5, v4, 4, v5
  v_add_u32 v224, s31, v5
  v_add_u32 v2, 64, v1
  v_mul_u32_u24 v3, 5462, v2
  v_lshrrev_b32 v3, 16, v3
  v_mul_u32_u24 v4, 12, v3
  v_sub_u32 v4, v2, v4
  v_mul_u32_u24 v5, 1152, v3
  v_lshl_add_u32 v251, v4, 4, v5
  v_lshrrev_b32 v6, 1, v3
  v_and_b32 v6, 2, v6
  v_xor_b32 v4, v4, v6
  v_lshl_add_u32 v5, v4, 4, v5
  v_add_u32 v225, s31, v5
  v_subrev_u32 v225, 1024, v225
  v_add_u32 v2, 128, v1
  v_mul_u32_u24 v3, 5462, v2
  v_lshrrev_b32 v3, 16, v3
  v_mul_u32_u24 v4, 12, v3
  v_sub_u32 v4, v2, v4
  v_mul_u32_u24 v5, 1152, v3
  v_lshl_add_u32 v252, v4, 4, v5
  v_lshrrev_b32 v6, 1, v3
  v_and_b32 v6, 2, v6
  v_xor_b32 v4, v4, v6
  v_lshl_add_u32 v5, v4, 4, v5
  v_add_u32 v226, s31, v5
  v_subrev_u32 v226, 2048, v226
  s_lshl_b32 s29, s64, 6
  s_lshl_b32 s30, s34, 5
  s_add_u32 s29, s29, s30
  s_lshl_b32 s30, s33, 4
  s_add_u32 s29, s29, s30
  s_mul_i32 s29, s29, 1152
  s_add_u32 s29, s29, s31
  v_add_u32 v250, s29, v250
  v_add_u32 v251, s29, v251
  v_add_u32 v252, s29, v252
  s_add_u32 s29, s24, 23
  s_mul_i32 s65, s29, 3072
  s_add_u32 s65, s65, 53248
  s_mul_i32 s66, s29, 18432
  s_cmp_eq_u32 s67, 1
  s_cbranch_scc1 standalone__linear_attn_block__prompt_kernel_q
  s_waitcnt vmcnt(10)
  s_barrier
  ds_read_b128 v[36:39], v22 offset:0
  ds_read_b64_tr_b16 v[52:53], v26 offset:0
  ds_read_b64_tr_b16 v[54:55], v26 offset:1536
  ds_read_b128 v[40:43], v22 offset:2048
  ds_read_b128 v[44:47], v23 offset:0
  ds_read_b128 v[48:51], v23 offset:2048
  ds_read_b64_tr_b16 v[56:57], v27 offset:0
  ds_read_b64_tr_b16 v[58:59], v27 offset:1536
  ds_read_b64_tr_b16 v[60:61], v28 offset:0
  ds_read_b64_tr_b16 v[62:63], v28 offset:1536
  ds_read_b64_tr_b16 v[64:65], v29 offset:0
  ds_read_b64_tr_b16 v[66:67], v29 offset:1536
  ds_read_b64_tr_b16 v[68:69], v30 offset:0
  ds_read_b64_tr_b16 v[70:71], v30 offset:1536
  s_mov_b32 s35, 0
  s_waitcnt lgkmcnt(11)
  v_mfma_f32_16x16x32_bf16 v[108:111], v[36:39], v[52:55], 1.0
  ds_read_b128 v[72:75], v24 offset:0
  ds_read_b64_tr_b16 v[88:89], v26 offset:12288
  s_waitcnt lgkmcnt(12)
  v_mfma_f32_16x16x32_bf16 v[112:115], v[40:43], v[52:55], 1.0
  ds_read_b64_tr_b16 v[90:91], v26 offset:13824
  s_add_u32 m0, s36, 32768
  s_mul_i32 s40, s39, 1728
  s_waitcnt lgkmcnt(12)
  v_mfma_f32_16x16x32_bf16 v[116:119], v[44:47], v[52:55], 1.0
  ds_read_b128 v[76:79], v24 offset:2048
  buffer_load_dwordx4 v12, s[8:11], s39 offen offset:0 lds
  s_waitcnt lgkmcnt(12)
  v_mfma_f32_16x16x32_bf16 v[120:123], v[48:51], v[52:55], 1.0
  ds_read_b128 v[80:83], v25 offset:0
  buffer_load_dwordx4 v13, s[8:11], s39 offen offset:1024 lds
  s_waitcnt lgkmcnt(11)
  v_mfma_f32_16x16x32_bf16 v[124:127], v[36:39], v[56:59], 1.0
  ds_read_b128 v[84:87], v25 offset:2048
  buffer_load_dwordx4 v14, s[8:11], s39 offen offset:2048 lds
  v_mfma_f32_16x16x32_bf16 v[128:131], v[40:43], v[56:59], 1.0
  ds_read_b64_tr_b16 v[92:93], v27 offset:12288
  buffer_load_dwordx4 v15, s[8:11], s39 offen offset:3072 lds
  v_mfma_f32_16x16x32_bf16 v[132:135], v[44:47], v[56:59], 1.0
  ds_read_b64_tr_b16 v[94:95], v27 offset:13824
  ds_read_b64_tr_b16 v[96:97], v28 offset:12288
  v_mfma_f32_16x16x32_bf16 v[136:139], v[48:51], v[56:59], 1.0
  ds_read_b64_tr_b16 v[98:99], v28 offset:13824
  s_add_u32 m0, s37, 49152
  s_add_u32 s39, s39, 128
  s_waitcnt lgkmcnt(14)
  v_mfma_f32_16x16x32_bf16 v[140:143], v[36:39], v[60:63], 0
  ds_read_b64_tr_b16 v[100:101], v29 offset:12288
  buffer_load_dwordx4 v16, s[12:15], s40 offen offset:0 lds
  v_mfma_f32_16x16x32_bf16 v[144:147], v[40:43], v[60:63], 0
  ds_read_b64_tr_b16 v[102:103], v29 offset:13824
  buffer_load_dwordx4 v17, s[12:15], s40 offen offset:1024 lds
  v_mfma_f32_16x16x32_bf16 v[148:151], v[44:47], v[60:63], 0
  ds_read_b64_tr_b16 v[104:105], v30 offset:12288
  buffer_load_dwordx4 v18, s[12:15], s40 offen offset:2048 lds
  v_mfma_f32_16x16x32_bf16 v[152:155], v[48:51], v[60:63], 0
  ds_read_b64_tr_b16 v[106:107], v30 offset:13824
  s_waitcnt lgkmcnt(15)
  v_mfma_f32_16x16x32_bf16 v[156:159], v[36:39], v[64:67], 0
  buffer_load_dwordx4 v19, s[12:15], s40 offen offset:3072 lds
  v_mfma_f32_16x16x32_bf16 v[160:163], v[40:43], v[64:67], 0
  s_add_u32 m0, s37, 53248
  s_nop 0
  v_mfma_f32_16x16x32_bf16 v[164:167], v[44:47], v[64:67], 0
  buffer_load_dwordx4 v20, s[12:15], s40 offen offset:0 lds
  v_mfma_f32_16x16x32_bf16 v[168:171], v[48:51], v[64:67], 0
  buffer_load_dwordx4 v21, s[12:15], s40 offen offset:1024 lds
  s_waitcnt lgkmcnt(14)
  v_mfma_f32_16x16x32_bf16 v[172:175], v[36:39], v[68:71], v[220:223]
  v_mfma_f32_16x16x32_bf16 v[176:179], v[40:43], v[68:71], v[220:223]
standalone__linear_attn_block__prompt_kernel_kv_loop:
  s_waitcnt lgkmcnt(11)
  v_mfma_f32_16x16x32_bf16 v[108:111], v[72:75], v[88:91], v[108:111]
  s_waitcnt lgkmcnt(10)
  v_mfma_f32_16x16x32_bf16 v[112:115], v[76:79], v[88:91], v[112:115]
  s_waitcnt vmcnt(10) lgkmcnt(0)
  s_barrier
  v_mfma_f32_16x16x32_bf16 v[116:119], v[80:83], v[88:91], v[116:119]
  ds_read_b128 v[36:39], v22 offset:16384
  ds_read_b64_tr_b16 v[52:53], v26 offset:24576
  v_mfma_f32_16x16x32_bf16 v[120:123], v[84:87], v[88:91], v[120:123]
  ds_read_b64_tr_b16 v[54:55], v26 offset:26112
  s_add_u32 m0, s36, 0
  s_mul_i32 s40, s39, 1728
  v_mfma_f32_16x16x32_bf16 v[124:127], v[72:75], v[92:95], v[124:127]
  ds_read_b128 v[40:43], v22 offset:18432
  v_mfma_f32_16x16x32_bf16 v[128:131], v[76:79], v[92:95], v[128:131]
  ds_read_b128 v[44:47], v23 offset:16384
  v_mfma_f32_16x16x32_bf16 v[132:135], v[80:83], v[92:95], v[132:135]
  ds_read_b128 v[48:51], v23 offset:18432
  buffer_load_dwordx4 v12, s[8:11], s39 offen offset:0 lds
  v_mfma_f32_16x16x32_bf16 v[136:139], v[84:87], v[92:95], v[136:139]
  ds_read_b64_tr_b16 v[56:57], v27 offset:24576
  v_mfma_f32_16x16x32_bf16 v[140:143], v[72:75], v[96:99], v[140:143]
  ds_read_b64_tr_b16 v[58:59], v27 offset:26112
  ds_read_b64_tr_b16 v[60:61], v28 offset:24576
  v_mfma_f32_16x16x32_bf16 v[144:147], v[76:79], v[96:99], v[144:147]
  ds_read_b64_tr_b16 v[62:63], v28 offset:26112
  buffer_load_dwordx4 v13, s[8:11], s39 offen offset:1024 lds
  v_mfma_f32_16x16x32_bf16 v[148:151], v[80:83], v[96:99], v[148:151]
  ds_read_b64_tr_b16 v[64:65], v29 offset:24576
  v_mfma_f32_16x16x32_bf16 v[152:155], v[84:87], v[96:99], v[152:155]
  ds_read_b64_tr_b16 v[66:67], v29 offset:26112
  v_mfma_f32_16x16x32_bf16 v[156:159], v[72:75], v[100:103], v[156:159]
  ds_read_b64_tr_b16 v[68:69], v30 offset:24576
  buffer_load_dwordx4 v14, s[8:11], s39 offen offset:2048 lds
  v_mfma_f32_16x16x32_bf16 v[160:163], v[76:79], v[100:103], v[160:163]
  ds_read_b64_tr_b16 v[70:71], v30 offset:26112
  v_mfma_f32_16x16x32_bf16 v[164:167], v[80:83], v[100:103], v[164:167]
  v_mfma_f32_16x16x32_bf16 v[168:171], v[84:87], v[100:103], v[168:171]
  buffer_load_dwordx4 v15, s[8:11], s39 offen offset:3072 lds
  v_mfma_f32_16x16x32_bf16 v[172:175], v[72:75], v[104:107], v[172:175]
  v_mfma_f32_16x16x32_bf16 v[176:179], v[76:79], v[104:107], v[176:179]
  s_waitcnt lgkmcnt(11)
  v_mfma_f32_16x16x32_bf16 v[108:111], v[36:39], v[52:55], v[108:111]
  ds_read_b128 v[72:75], v24 offset:16384
  ds_read_b64_tr_b16 v[88:89], v26 offset:36864
  s_waitcnt lgkmcnt(12)
  v_mfma_f32_16x16x32_bf16 v[112:115], v[40:43], v[52:55], v[112:115]
  ds_read_b64_tr_b16 v[90:91], v26 offset:38400
  s_add_u32 m0, s37, 0
  s_add_u32 s39, s39, 128
  s_waitcnt lgkmcnt(12)
  v_mfma_f32_16x16x32_bf16 v[116:119], v[44:47], v[52:55], v[116:119]
  ds_read_b128 v[76:79], v24 offset:18432
  s_waitcnt lgkmcnt(12)
  v_mfma_f32_16x16x32_bf16 v[120:123], v[48:51], v[52:55], v[120:123]
  ds_read_b128 v[80:83], v25 offset:16384
  buffer_load_dwordx4 v16, s[12:15], s40 offen offset:0 lds
  s_waitcnt lgkmcnt(11)
  v_mfma_f32_16x16x32_bf16 v[124:127], v[36:39], v[56:59], v[124:127]
  ds_read_b128 v[84:87], v25 offset:18432
  v_mfma_f32_16x16x32_bf16 v[128:131], v[40:43], v[56:59], v[128:131]
  ds_read_b64_tr_b16 v[92:93], v27 offset:36864
  buffer_load_dwordx4 v17, s[12:15], s40 offen offset:1024 lds
  v_mfma_f32_16x16x32_bf16 v[132:135], v[44:47], v[56:59], v[132:135]
  ds_read_b64_tr_b16 v[94:95], v27 offset:38400
  ds_read_b64_tr_b16 v[96:97], v28 offset:36864
  v_mfma_f32_16x16x32_bf16 v[136:139], v[48:51], v[56:59], v[136:139]
  ds_read_b64_tr_b16 v[98:99], v28 offset:38400
  buffer_load_dwordx4 v18, s[12:15], s40 offen offset:2048 lds
  s_waitcnt lgkmcnt(14)
  v_mfma_f32_16x16x32_bf16 v[140:143], v[36:39], v[60:63], v[140:143]
  ds_read_b64_tr_b16 v[100:101], v29 offset:36864
  v_mfma_f32_16x16x32_bf16 v[144:147], v[40:43], v[60:63], v[144:147]
  ds_read_b64_tr_b16 v[102:103], v29 offset:38400
  buffer_load_dwordx4 v19, s[12:15], s40 offen offset:3072 lds
  v_mfma_f32_16x16x32_bf16 v[148:151], v[44:47], v[60:63], v[148:151]
  ds_read_b64_tr_b16 v[104:105], v30 offset:36864
  v_mfma_f32_16x16x32_bf16 v[152:155], v[48:51], v[60:63], v[152:155]
  ds_read_b64_tr_b16 v[106:107], v30 offset:38400
  s_add_u32 m0, s37, 4096
  s_nop 0
  s_waitcnt lgkmcnt(15)
  v_mfma_f32_16x16x32_bf16 v[156:159], v[36:39], v[64:67], v[156:159]
  v_mfma_f32_16x16x32_bf16 v[160:163], v[40:43], v[64:67], v[160:163]
  buffer_load_dwordx4 v20, s[12:15], s40 offen offset:0 lds
  v_mfma_f32_16x16x32_bf16 v[164:167], v[44:47], v[64:67], v[164:167]
  v_mfma_f32_16x16x32_bf16 v[168:171], v[48:51], v[64:67], v[168:171]
  buffer_load_dwordx4 v21, s[12:15], s40 offen offset:1024 lds
  s_waitcnt lgkmcnt(14)
  v_mfma_f32_16x16x32_bf16 v[172:175], v[36:39], v[68:71], v[172:175]
  v_mfma_f32_16x16x32_bf16 v[176:179], v[40:43], v[68:71], v[176:179]
  s_waitcnt lgkmcnt(11)
  v_mfma_f32_16x16x32_bf16 v[108:111], v[72:75], v[88:91], v[108:111]
  s_waitcnt lgkmcnt(10)
  v_mfma_f32_16x16x32_bf16 v[112:115], v[76:79], v[88:91], v[112:115]
  s_waitcnt vmcnt(10) lgkmcnt(0)
  s_barrier
  v_mfma_f32_16x16x32_bf16 v[116:119], v[80:83], v[88:91], v[116:119]
  ds_read_b128 v[36:39], v22 offset:32768
  ds_read_b64_tr_b16 v[52:53], v26 offset:49152
  v_mfma_f32_16x16x32_bf16 v[120:123], v[84:87], v[88:91], v[120:123]
  ds_read_b64_tr_b16 v[54:55], v26 offset:50688
  s_add_u32 m0, s36, 16384
  s_mul_i32 s40, s39, 1728
  v_mfma_f32_16x16x32_bf16 v[124:127], v[72:75], v[92:95], v[124:127]
  ds_read_b128 v[40:43], v22 offset:34816
  v_mfma_f32_16x16x32_bf16 v[128:131], v[76:79], v[92:95], v[128:131]
  ds_read_b128 v[44:47], v23 offset:32768
  v_mfma_f32_16x16x32_bf16 v[132:135], v[80:83], v[92:95], v[132:135]
  ds_read_b128 v[48:51], v23 offset:34816
  buffer_load_dwordx4 v12, s[8:11], s39 offen offset:0 lds
  v_mfma_f32_16x16x32_bf16 v[136:139], v[84:87], v[92:95], v[136:139]
  ds_read_b64_tr_b16 v[56:57], v27 offset:49152
  v_mfma_f32_16x16x32_bf16 v[140:143], v[72:75], v[96:99], v[140:143]
  ds_read_b64_tr_b16 v[58:59], v27 offset:50688
  ds_read_b64_tr_b16 v[60:61], v28 offset:49152
  v_mfma_f32_16x16x32_bf16 v[144:147], v[76:79], v[96:99], v[144:147]
  ds_read_b64_tr_b16 v[62:63], v28 offset:50688
  buffer_load_dwordx4 v13, s[8:11], s39 offen offset:1024 lds
  v_mfma_f32_16x16x32_bf16 v[148:151], v[80:83], v[96:99], v[148:151]
  ds_read_b64_tr_b16 v[64:65], v29 offset:49152
  v_mfma_f32_16x16x32_bf16 v[152:155], v[84:87], v[96:99], v[152:155]
  ds_read_b64_tr_b16 v[66:67], v29 offset:50688
  v_mfma_f32_16x16x32_bf16 v[156:159], v[72:75], v[100:103], v[156:159]
  ds_read_b64_tr_b16 v[68:69], v30 offset:49152
  buffer_load_dwordx4 v14, s[8:11], s39 offen offset:2048 lds
  v_mfma_f32_16x16x32_bf16 v[160:163], v[76:79], v[100:103], v[160:163]
  ds_read_b64_tr_b16 v[70:71], v30 offset:50688
  v_mfma_f32_16x16x32_bf16 v[164:167], v[80:83], v[100:103], v[164:167]
  v_mfma_f32_16x16x32_bf16 v[168:171], v[84:87], v[100:103], v[168:171]
  buffer_load_dwordx4 v15, s[8:11], s39 offen offset:3072 lds
  v_mfma_f32_16x16x32_bf16 v[172:175], v[72:75], v[104:107], v[172:175]
  v_mfma_f32_16x16x32_bf16 v[176:179], v[76:79], v[104:107], v[176:179]
  s_waitcnt lgkmcnt(11)
  v_mfma_f32_16x16x32_bf16 v[108:111], v[36:39], v[52:55], v[108:111]
  ds_read_b128 v[72:75], v24 offset:32768
  ds_read_b64_tr_b16 v[88:89], v26 offset:61440
  s_waitcnt lgkmcnt(12)
  v_mfma_f32_16x16x32_bf16 v[112:115], v[40:43], v[52:55], v[112:115]
  ds_read_b64_tr_b16 v[90:91], v26 offset:62976
  s_add_u32 m0, s37, 24576
  s_add_u32 s39, s39, 128
  s_waitcnt lgkmcnt(12)
  v_mfma_f32_16x16x32_bf16 v[116:119], v[44:47], v[52:55], v[116:119]
  ds_read_b128 v[76:79], v24 offset:34816
  s_waitcnt lgkmcnt(12)
  v_mfma_f32_16x16x32_bf16 v[120:123], v[48:51], v[52:55], v[120:123]
  ds_read_b128 v[80:83], v25 offset:32768
  buffer_load_dwordx4 v16, s[12:15], s40 offen offset:0 lds
  s_waitcnt lgkmcnt(11)
  v_mfma_f32_16x16x32_bf16 v[124:127], v[36:39], v[56:59], v[124:127]
  ds_read_b128 v[84:87], v25 offset:34816
  v_mfma_f32_16x16x32_bf16 v[128:131], v[40:43], v[56:59], v[128:131]
  ds_read_b64_tr_b16 v[92:93], v27 offset:61440
  buffer_load_dwordx4 v17, s[12:15], s40 offen offset:1024 lds
  v_mfma_f32_16x16x32_bf16 v[132:135], v[44:47], v[56:59], v[132:135]
  ds_read_b64_tr_b16 v[94:95], v27 offset:62976
  ds_read_b64_tr_b16 v[96:97], v28 offset:61440
  v_mfma_f32_16x16x32_bf16 v[136:139], v[48:51], v[56:59], v[136:139]
  ds_read_b64_tr_b16 v[98:99], v28 offset:62976
  buffer_load_dwordx4 v18, s[12:15], s40 offen offset:2048 lds
  s_waitcnt lgkmcnt(14)
  v_mfma_f32_16x16x32_bf16 v[140:143], v[36:39], v[60:63], v[140:143]
  ds_read_b64_tr_b16 v[100:101], v29 offset:61440
  v_mfma_f32_16x16x32_bf16 v[144:147], v[40:43], v[60:63], v[144:147]
  ds_read_b64_tr_b16 v[102:103], v29 offset:62976
  buffer_load_dwordx4 v19, s[12:15], s40 offen offset:3072 lds
  v_mfma_f32_16x16x32_bf16 v[148:151], v[44:47], v[60:63], v[148:151]
  ds_read_b64_tr_b16 v[104:105], v30 offset:61440
  v_mfma_f32_16x16x32_bf16 v[152:155], v[48:51], v[60:63], v[152:155]
  ds_read_b64_tr_b16 v[106:107], v30 offset:62976
  s_add_u32 m0, s37, 28672
  s_nop 0
  s_waitcnt lgkmcnt(15)
  v_mfma_f32_16x16x32_bf16 v[156:159], v[36:39], v[64:67], v[156:159]
  v_mfma_f32_16x16x32_bf16 v[160:163], v[40:43], v[64:67], v[160:163]
  buffer_load_dwordx4 v20, s[12:15], s40 offen offset:0 lds
  v_mfma_f32_16x16x32_bf16 v[164:167], v[44:47], v[64:67], v[164:167]
  v_mfma_f32_16x16x32_bf16 v[168:171], v[48:51], v[64:67], v[168:171]
  buffer_load_dwordx4 v21, s[12:15], s40 offen offset:1024 lds
  s_waitcnt lgkmcnt(14)
  v_mfma_f32_16x16x32_bf16 v[172:175], v[36:39], v[68:71], v[172:175]
  v_mfma_f32_16x16x32_bf16 v[176:179], v[40:43], v[68:71], v[176:179]
  s_waitcnt lgkmcnt(11)
  v_mfma_f32_16x16x32_bf16 v[108:111], v[72:75], v[88:91], v[108:111]
  s_waitcnt lgkmcnt(10)
  v_mfma_f32_16x16x32_bf16 v[112:115], v[76:79], v[88:91], v[112:115]
  s_waitcnt vmcnt(10) lgkmcnt(0)
  s_barrier
  v_mfma_f32_16x16x32_bf16 v[116:119], v[80:83], v[88:91], v[116:119]
  ds_read_b128 v[36:39], v22 offset:0
  ds_read_b64_tr_b16 v[52:53], v26 offset:0
  v_mfma_f32_16x16x32_bf16 v[120:123], v[84:87], v[88:91], v[120:123]
  ds_read_b64_tr_b16 v[54:55], v26 offset:1536
  s_add_u32 m0, s36, 32768
  s_mul_i32 s40, s39, 1728
  v_mfma_f32_16x16x32_bf16 v[124:127], v[72:75], v[92:95], v[124:127]
  ds_read_b128 v[40:43], v22 offset:2048
  v_mfma_f32_16x16x32_bf16 v[128:131], v[76:79], v[92:95], v[128:131]
  ds_read_b128 v[44:47], v23 offset:0
  v_mfma_f32_16x16x32_bf16 v[132:135], v[80:83], v[92:95], v[132:135]
  ds_read_b128 v[48:51], v23 offset:2048
  buffer_load_dwordx4 v12, s[8:11], s39 offen offset:0 lds
  v_mfma_f32_16x16x32_bf16 v[136:139], v[84:87], v[92:95], v[136:139]
  ds_read_b64_tr_b16 v[56:57], v27 offset:0
  v_mfma_f32_16x16x32_bf16 v[140:143], v[72:75], v[96:99], v[140:143]
  ds_read_b64_tr_b16 v[58:59], v27 offset:1536
  ds_read_b64_tr_b16 v[60:61], v28 offset:0
  v_mfma_f32_16x16x32_bf16 v[144:147], v[76:79], v[96:99], v[144:147]
  ds_read_b64_tr_b16 v[62:63], v28 offset:1536
  buffer_load_dwordx4 v13, s[8:11], s39 offen offset:1024 lds
  v_mfma_f32_16x16x32_bf16 v[148:151], v[80:83], v[96:99], v[148:151]
  ds_read_b64_tr_b16 v[64:65], v29 offset:0
  v_mfma_f32_16x16x32_bf16 v[152:155], v[84:87], v[96:99], v[152:155]
  ds_read_b64_tr_b16 v[66:67], v29 offset:1536
  v_mfma_f32_16x16x32_bf16 v[156:159], v[72:75], v[100:103], v[156:159]
  ds_read_b64_tr_b16 v[68:69], v30 offset:0
  buffer_load_dwordx4 v14, s[8:11], s39 offen offset:2048 lds
  v_mfma_f32_16x16x32_bf16 v[160:163], v[76:79], v[100:103], v[160:163]
  ds_read_b64_tr_b16 v[70:71], v30 offset:1536
  v_mfma_f32_16x16x32_bf16 v[164:167], v[80:83], v[100:103], v[164:167]
  v_mfma_f32_16x16x32_bf16 v[168:171], v[84:87], v[100:103], v[168:171]
  buffer_load_dwordx4 v15, s[8:11], s39 offen offset:3072 lds
  v_mfma_f32_16x16x32_bf16 v[172:175], v[72:75], v[104:107], v[172:175]
  v_mfma_f32_16x16x32_bf16 v[176:179], v[76:79], v[104:107], v[176:179]
  s_waitcnt lgkmcnt(11)
  v_mfma_f32_16x16x32_bf16 v[108:111], v[36:39], v[52:55], v[108:111]
  ds_read_b128 v[72:75], v24 offset:0
  ds_read_b64_tr_b16 v[88:89], v26 offset:12288
  s_waitcnt lgkmcnt(12)
  v_mfma_f32_16x16x32_bf16 v[112:115], v[40:43], v[52:55], v[112:115]
  ds_read_b64_tr_b16 v[90:91], v26 offset:13824
  s_add_u32 m0, s37, 49152
  s_add_u32 s39, s39, 128
  s_waitcnt lgkmcnt(12)
  v_mfma_f32_16x16x32_bf16 v[116:119], v[44:47], v[52:55], v[116:119]
  ds_read_b128 v[76:79], v24 offset:2048
  s_waitcnt lgkmcnt(12)
  v_mfma_f32_16x16x32_bf16 v[120:123], v[48:51], v[52:55], v[120:123]
  ds_read_b128 v[80:83], v25 offset:0
  buffer_load_dwordx4 v16, s[12:15], s40 offen offset:0 lds
  s_waitcnt lgkmcnt(11)
  v_mfma_f32_16x16x32_bf16 v[124:127], v[36:39], v[56:59], v[124:127]
  ds_read_b128 v[84:87], v25 offset:2048
  v_mfma_f32_16x16x32_bf16 v[128:131], v[40:43], v[56:59], v[128:131]
  ds_read_b64_tr_b16 v[92:93], v27 offset:12288
  buffer_load_dwordx4 v17, s[12:15], s40 offen offset:1024 lds
  v_mfma_f32_16x16x32_bf16 v[132:135], v[44:47], v[56:59], v[132:135]
  ds_read_b64_tr_b16 v[94:95], v27 offset:13824
  ds_read_b64_tr_b16 v[96:97], v28 offset:12288
  v_mfma_f32_16x16x32_bf16 v[136:139], v[48:51], v[56:59], v[136:139]
  ds_read_b64_tr_b16 v[98:99], v28 offset:13824
  buffer_load_dwordx4 v18, s[12:15], s40 offen offset:2048 lds
  s_waitcnt lgkmcnt(14)
  v_mfma_f32_16x16x32_bf16 v[140:143], v[36:39], v[60:63], v[140:143]
  ds_read_b64_tr_b16 v[100:101], v29 offset:12288
  v_mfma_f32_16x16x32_bf16 v[144:147], v[40:43], v[60:63], v[144:147]
  ds_read_b64_tr_b16 v[102:103], v29 offset:13824
  buffer_load_dwordx4 v19, s[12:15], s40 offen offset:3072 lds
  v_mfma_f32_16x16x32_bf16 v[148:151], v[44:47], v[60:63], v[148:151]
  ds_read_b64_tr_b16 v[104:105], v30 offset:12288
  v_mfma_f32_16x16x32_bf16 v[152:155], v[48:51], v[60:63], v[152:155]
  ds_read_b64_tr_b16 v[106:107], v30 offset:13824
  s_add_u32 m0, s37, 53248
  s_nop 0
  s_waitcnt lgkmcnt(15)
  v_mfma_f32_16x16x32_bf16 v[156:159], v[36:39], v[64:67], v[156:159]
  v_mfma_f32_16x16x32_bf16 v[160:163], v[40:43], v[64:67], v[160:163]
  buffer_load_dwordx4 v20, s[12:15], s40 offen offset:0 lds
  v_mfma_f32_16x16x32_bf16 v[164:167], v[44:47], v[64:67], v[164:167]
  v_mfma_f32_16x16x32_bf16 v[168:171], v[48:51], v[64:67], v[168:171]
  buffer_load_dwordx4 v21, s[12:15], s40 offen offset:1024 lds
  s_waitcnt lgkmcnt(14)
  v_mfma_f32_16x16x32_bf16 v[172:175], v[36:39], v[68:71], v[172:175]
  v_mfma_f32_16x16x32_bf16 v[176:179], v[40:43], v[68:71], v[176:179]
  s_add_u32 s35, s35, 1
  s_cmp_lt_u32 s35, 2
  s_cbranch_scc1 standalone__linear_attn_block__prompt_kernel_kv_loop
  s_waitcnt lgkmcnt(11)
  v_mfma_f32_16x16x32_bf16 v[108:111], v[72:75], v[88:91], v[108:111]
  s_waitcnt lgkmcnt(10)
  v_mfma_f32_16x16x32_bf16 v[112:115], v[76:79], v[88:91], v[112:115]
  s_waitcnt vmcnt(10) lgkmcnt(0)
  s_barrier
  v_mfma_f32_16x16x32_bf16 v[116:119], v[80:83], v[88:91], v[116:119]
  ds_read_b128 v[36:39], v22 offset:16384
  ds_read_b64_tr_b16 v[52:53], v26 offset:24576
  v_mfma_f32_16x16x32_bf16 v[120:123], v[84:87], v[88:91], v[120:123]
  ds_read_b64_tr_b16 v[54:55], v26 offset:26112
  s_mov_b32 m0, s65
  s_add_u32 s65, s65, 12288
  v_mfma_f32_16x16x32_bf16 v[124:127], v[72:75], v[92:95], v[124:127]
  ds_read_b128 v[40:43], v22 offset:18432
  buffer_load_dwordx4 v224, s[80:83], s66 offen lds
  v_mfma_f32_16x16x32_bf16 v[128:131], v[76:79], v[92:95], v[128:131]
  ds_read_b128 v[44:47], v23 offset:16384
  v_mfma_f32_16x16x32_bf16 v[132:135], v[80:83], v[92:95], v[132:135]
  ds_read_b128 v[48:51], v23 offset:18432
  buffer_load_dwordx4 v225, s[80:83], s66 offen offset:1024 lds
  v_mfma_f32_16x16x32_bf16 v[136:139], v[84:87], v[92:95], v[136:139]
  ds_read_b64_tr_b16 v[56:57], v27 offset:24576
  v_mfma_f32_16x16x32_bf16 v[140:143], v[72:75], v[96:99], v[140:143]
  ds_read_b64_tr_b16 v[58:59], v27 offset:26112
  ds_read_b64_tr_b16 v[60:61], v28 offset:24576
  buffer_load_dwordx4 v226, s[80:83], s66 offen offset:2048 lds
  s_add_u32 s66, s66, 73728
  v_mfma_f32_16x16x32_bf16 v[144:147], v[76:79], v[96:99], v[144:147]
  ds_read_b64_tr_b16 v[62:63], v28 offset:26112
  v_mfma_f32_16x16x32_bf16 v[148:151], v[80:83], v[96:99], v[148:151]
  ds_read_b64_tr_b16 v[64:65], v29 offset:24576
  s_mov_b32 m0, s65
  s_add_u32 s65, s65, 12288
  v_mfma_f32_16x16x32_bf16 v[152:155], v[84:87], v[96:99], v[152:155]
  ds_read_b64_tr_b16 v[66:67], v29 offset:26112
  v_mfma_f32_16x16x32_bf16 v[156:159], v[72:75], v[100:103], v[156:159]
  ds_read_b64_tr_b16 v[68:69], v30 offset:24576
  buffer_load_dwordx4 v224, s[80:83], s66 offen lds
  v_mfma_f32_16x16x32_bf16 v[160:163], v[76:79], v[100:103], v[160:163]
  ds_read_b64_tr_b16 v[70:71], v30 offset:26112
  v_mfma_f32_16x16x32_bf16 v[164:167], v[80:83], v[100:103], v[164:167]
  buffer_load_dwordx4 v225, s[80:83], s66 offen offset:1024 lds
  v_mfma_f32_16x16x32_bf16 v[168:171], v[84:87], v[100:103], v[168:171]
  v_mfma_f32_16x16x32_bf16 v[172:175], v[72:75], v[104:107], v[172:175]
  buffer_load_dwordx4 v226, s[80:83], s66 offen offset:2048 lds
  s_add_u32 s66, s66, 73728
  v_mfma_f32_16x16x32_bf16 v[176:179], v[76:79], v[104:107], v[176:179]
  s_waitcnt lgkmcnt(11)
  v_mfma_f32_16x16x32_bf16 v[108:111], v[36:39], v[52:55], v[108:111]
  ds_read_b128 v[72:75], v24 offset:16384
  ds_read_b64_tr_b16 v[88:89], v26 offset:36864
  s_waitcnt lgkmcnt(12)
  v_mfma_f32_16x16x32_bf16 v[112:115], v[40:43], v[52:55], v[112:115]
  ds_read_b64_tr_b16 v[90:91], v26 offset:38400
  s_mov_b32 m0, s65
  s_add_u32 s65, s65, 12288
  s_waitcnt lgkmcnt(12)
  v_mfma_f32_16x16x32_bf16 v[116:119], v[44:47], v[52:55], v[116:119]
  ds_read_b128 v[76:79], v24 offset:18432
  buffer_load_dwordx4 v224, s[80:83], s66 offen lds
  s_waitcnt lgkmcnt(12)
  v_mfma_f32_16x16x32_bf16 v[120:123], v[48:51], v[52:55], v[120:123]
  ds_read_b128 v[80:83], v25 offset:16384
  s_waitcnt lgkmcnt(11)
  v_mfma_f32_16x16x32_bf16 v[124:127], v[36:39], v[56:59], v[124:127]
  ds_read_b128 v[84:87], v25 offset:18432
  buffer_load_dwordx4 v225, s[80:83], s66 offen offset:1024 lds
  v_mfma_f32_16x16x32_bf16 v[128:131], v[40:43], v[56:59], v[128:131]
  ds_read_b64_tr_b16 v[92:93], v27 offset:36864
  buffer_load_dwordx4 v226, s[80:83], s66 offen offset:2048 lds
  s_add_u32 s66, s66, 73728
  v_mfma_f32_16x16x32_bf16 v[132:135], v[44:47], v[56:59], v[132:135]
  ds_read_b64_tr_b16 v[94:95], v27 offset:38400
  ds_read_b64_tr_b16 v[96:97], v28 offset:36864
  v_mfma_f32_16x16x32_bf16 v[136:139], v[48:51], v[56:59], v[136:139]
  ds_read_b64_tr_b16 v[98:99], v28 offset:38400
  s_cmp_ge_u32 s65, 163840
  s_cselect_b32 s18, 110592, 0
  s_cselect_b32 s19, 663552, 0
  s_sub_u32 s65, s65, s18
  s_sub_u32 s66, s66, s19
  s_waitcnt lgkmcnt(14)
  v_mfma_f32_16x16x32_bf16 v[140:143], v[36:39], v[60:63], v[140:143]
  ds_read_b64_tr_b16 v[100:101], v29 offset:36864
  v_mfma_f32_16x16x32_bf16 v[144:147], v[40:43], v[60:63], v[144:147]
  ds_read_b64_tr_b16 v[102:103], v29 offset:38400
  s_mov_b32 m0, s65
  s_add_u32 s65, s65, 12288
  v_mfma_f32_16x16x32_bf16 v[148:151], v[44:47], v[60:63], v[148:151]
  ds_read_b64_tr_b16 v[104:105], v30 offset:36864
  buffer_load_dwordx4 v224, s[80:83], s66 offen lds
  v_mfma_f32_16x16x32_bf16 v[152:155], v[48:51], v[60:63], v[152:155]
  ds_read_b64_tr_b16 v[106:107], v30 offset:38400
  s_waitcnt lgkmcnt(15)
  v_mfma_f32_16x16x32_bf16 v[156:159], v[36:39], v[64:67], v[156:159]
  buffer_load_dwordx4 v225, s[80:83], s66 offen offset:1024 lds
  v_mfma_f32_16x16x32_bf16 v[160:163], v[40:43], v[64:67], v[160:163]
  buffer_load_dwordx4 v226, s[80:83], s66 offen offset:2048 lds
  s_add_u32 s66, s66, 73728
  v_mfma_f32_16x16x32_bf16 v[164:167], v[44:47], v[64:67], v[164:167]
  v_mfma_f32_16x16x32_bf16 v[168:171], v[48:51], v[64:67], v[168:171]
  s_cmp_ge_u32 s65, 163840
  s_cselect_b32 s18, 110592, 0
  s_cselect_b32 s19, 663552, 0
  s_sub_u32 s65, s65, s18
  s_sub_u32 s66, s66, s19
  s_waitcnt lgkmcnt(14)
  v_mfma_f32_16x16x32_bf16 v[172:175], v[36:39], v[68:71], v[172:175]
  v_mfma_f32_16x16x32_bf16 v[176:179], v[40:43], v[68:71], v[176:179]
  s_waitcnt lgkmcnt(11)
  v_mfma_f32_16x16x32_bf16 v[108:111], v[72:75], v[88:91], v[108:111]
  s_waitcnt lgkmcnt(10)
  v_mfma_f32_16x16x32_bf16 v[112:115], v[76:79], v[88:91], v[112:115]
  s_waitcnt vmcnt(12) lgkmcnt(0)
  s_barrier
  v_mfma_f32_16x16x32_bf16 v[116:119], v[80:83], v[88:91], v[116:119]
  ds_read_b128 v[36:39], v22 offset:32768
  ds_read_b64_tr_b16 v[52:53], v26 offset:49152
  v_mfma_f32_16x16x32_bf16 v[120:123], v[84:87], v[88:91], v[120:123]
  ds_read_b64_tr_b16 v[54:55], v26 offset:50688
  s_mov_b32 m0, s65
  s_add_u32 s65, s65, 12288
  v_mfma_f32_16x16x32_bf16 v[124:127], v[72:75], v[92:95], v[124:127]
  ds_read_b128 v[40:43], v22 offset:34816
  v_mfma_f32_16x16x32_bf16 v[128:131], v[76:79], v[92:95], v[128:131]
  ds_read_b128 v[44:47], v23 offset:32768
  v_mfma_f32_16x16x32_bf16 v[132:135], v[80:83], v[92:95], v[132:135]
  ds_read_b128 v[48:51], v23 offset:34816
  buffer_load_dwordx4 v224, s[80:83], s66 offen lds
  v_mfma_f32_16x16x32_bf16 v[136:139], v[84:87], v[92:95], v[136:139]
  ds_read_b64_tr_b16 v[56:57], v27 offset:49152
  v_mfma_f32_16x16x32_bf16 v[140:143], v[72:75], v[96:99], v[140:143]
  ds_read_b64_tr_b16 v[58:59], v27 offset:50688
  ds_read_b64_tr_b16 v[60:61], v28 offset:49152
  v_mfma_f32_16x16x32_bf16 v[144:147], v[76:79], v[96:99], v[144:147]
  ds_read_b64_tr_b16 v[62:63], v28 offset:50688
  v_mfma_f32_16x16x32_bf16 v[148:151], v[80:83], v[96:99], v[148:151]
  ds_read_b64_tr_b16 v[64:65], v29 offset:49152
  buffer_load_dwordx4 v225, s[80:83], s66 offen offset:1024 lds
  v_mfma_f32_16x16x32_bf16 v[152:155], v[84:87], v[96:99], v[152:155]
  ds_read_b64_tr_b16 v[66:67], v29 offset:50688
  v_mfma_f32_16x16x32_bf16 v[156:159], v[72:75], v[100:103], v[156:159]
  ds_read_b64_tr_b16 v[68:69], v30 offset:49152
  v_mfma_f32_16x16x32_bf16 v[160:163], v[76:79], v[100:103], v[160:163]
  ds_read_b64_tr_b16 v[70:71], v30 offset:50688
  v_mfma_f32_16x16x32_bf16 v[164:167], v[80:83], v[100:103], v[164:167]
  buffer_load_dwordx4 v226, s[80:83], s66 offen offset:2048 lds
  s_add_u32 s66, s66, 73728
  v_mfma_f32_16x16x32_bf16 v[168:171], v[84:87], v[100:103], v[168:171]
  v_mfma_f32_16x16x32_bf16 v[172:175], v[72:75], v[104:107], v[172:175]
  v_mfma_f32_16x16x32_bf16 v[176:179], v[76:79], v[104:107], v[176:179]
  s_waitcnt lgkmcnt(11)
  v_mfma_f32_16x16x32_bf16 v[108:111], v[36:39], v[52:55], v[108:111]
  ds_read_b128 v[72:75], v24 offset:32768
  ds_read_b64_tr_b16 v[88:89], v26 offset:61440
  s_waitcnt lgkmcnt(12)
  v_mfma_f32_16x16x32_bf16 v[112:115], v[40:43], v[52:55], v[112:115]
  ds_read_b64_tr_b16 v[90:91], v26 offset:62976
  s_mov_b32 m0, s65
  s_add_u32 s65, s65, 12288
  s_waitcnt lgkmcnt(12)
  v_mfma_f32_16x16x32_bf16 v[116:119], v[44:47], v[52:55], v[116:119]
  ds_read_b128 v[76:79], v24 offset:34816
  s_waitcnt lgkmcnt(12)
  v_mfma_f32_16x16x32_bf16 v[120:123], v[48:51], v[52:55], v[120:123]
  ds_read_b128 v[80:83], v25 offset:32768
  s_waitcnt lgkmcnt(11)
  v_mfma_f32_16x16x32_bf16 v[124:127], v[36:39], v[56:59], v[124:127]
  ds_read_b128 v[84:87], v25 offset:34816
  v_mfma_f32_16x16x32_bf16 v[128:131], v[40:43], v[56:59], v[128:131]
  ds_read_b64_tr_b16 v[92:93], v27 offset:61440
  buffer_load_dwordx4 v224, s[80:83], s66 offen lds
  v_mfma_f32_16x16x32_bf16 v[132:135], v[44:47], v[56:59], v[132:135]
  ds_read_b64_tr_b16 v[94:95], v27 offset:62976
  ds_read_b64_tr_b16 v[96:97], v28 offset:61440
  v_mfma_f32_16x16x32_bf16 v[136:139], v[48:51], v[56:59], v[136:139]
  ds_read_b64_tr_b16 v[98:99], v28 offset:62976
  s_waitcnt lgkmcnt(14)
  v_mfma_f32_16x16x32_bf16 v[140:143], v[36:39], v[60:63], v[140:143]
  ds_read_b64_tr_b16 v[100:101], v29 offset:61440
  v_mfma_f32_16x16x32_bf16 v[144:147], v[40:43], v[60:63], v[144:147]
  ds_read_b64_tr_b16 v[102:103], v29 offset:62976
  buffer_load_dwordx4 v225, s[80:83], s66 offen offset:1024 lds
  v_mfma_f32_16x16x32_bf16 v[148:151], v[44:47], v[60:63], v[148:151]
  ds_read_b64_tr_b16 v[104:105], v30 offset:61440
  v_mfma_f32_16x16x32_bf16 v[152:155], v[48:51], v[60:63], v[152:155]
  ds_read_b64_tr_b16 v[106:107], v30 offset:62976
  s_waitcnt lgkmcnt(15)
  v_mfma_f32_16x16x32_bf16 v[156:159], v[36:39], v[64:67], v[156:159]
  v_mfma_f32_16x16x32_bf16 v[160:163], v[40:43], v[64:67], v[160:163]
  buffer_load_dwordx4 v226, s[80:83], s66 offen offset:2048 lds
  s_add_u32 s66, s66, 73728
  v_mfma_f32_16x16x32_bf16 v[164:167], v[44:47], v[64:67], v[164:167]
  v_mfma_f32_16x16x32_bf16 v[168:171], v[48:51], v[64:67], v[168:171]
  s_waitcnt lgkmcnt(14)
  v_mfma_f32_16x16x32_bf16 v[172:175], v[36:39], v[68:71], v[172:175]
  v_mfma_f32_16x16x32_bf16 v[176:179], v[40:43], v[68:71], v[176:179]
  s_waitcnt lgkmcnt(0)
  s_barrier
  v_mfma_f32_16x16x32_bf16 v[108:111], v[72:75], v[88:91], v[108:111]
  v_and_b32 v32, 7, v1
  v_lshlrev_b32 v32, 2, v32
  v_mfma_f32_16x16x32_bf16 v[112:115], v[76:79], v[88:91], v[112:115]
  global_load_dword v254, v32, s[76:77] sc1
  v_mfma_f32_16x16x32_bf16 v[116:119], v[80:83], v[88:91], v[116:119]
  v_mfma_f32_16x16x32_bf16 v[120:123], v[84:87], v[88:91], v[120:123]
  s_lshl_b32 s29, s44, 13
  s_lshl_b32 s30, s45, 1
  s_add_u32 s31, s30, s44
  s_lshl_b32 s31, s31, 10
  v_mfma_f32_16x16x32_bf16 v[124:127], v[72:75], v[92:95], v[124:127]
  v_mfma_f32_16x16x32_bf16 v[128:131], v[76:79], v[92:95], v[128:131]
  s_xor_b32 s63, s31, 1024
  v_lshlrev_b32 v7, 4, v1
  v_add_u32 v7, 0, v7
  v_mfma_f32_16x16x32_bf16 v[132:135], v[80:83], v[92:95], v[132:135]
  v_mfma_f32_16x16x32_bf16 v[136:139], v[84:87], v[92:95], v[136:139]
  s_add_u32 s62, s29, s31
  v_add_u32 v22, s62, v7
  v_mfma_f32_16x16x32_bf16 v[172:175], v[72:75], v[104:107], v[172:175]
  v_mfma_f32_16x16x32_bf16 v[176:179], v[76:79], v[104:107], v[176:179]
  s_add_u32 s62, s29, s63
  v_add_u32 v23, s62, v7
  v_mfma_f32_16x16x32_bf16 v[140:143], v[72:75], v[96:99], v[140:143]
  v_add_u32 v24, s31, v7
  v_mfma_f32_16x16x32_bf16 v[144:147], v[76:79], v[96:99], v[144:147]
  v_mfma_f32_16x16x32_bf16 v[148:151], v[80:83], v[96:99], v[148:151]
  v_mov_b32 v216, 0
  v_mov_b32 v217, 0
  v_mov_b32 v218, 0
  v_mov_b32 v219, 0
  v_lshlrev_b32 v6, 4, v0
  v_add_u32 v6, 36864, v6
  v_mfma_f32_16x16x32_bf16 v[152:155], v[84:87], v[96:99], v[152:155]
  v_mfma_f32_16x16x32_bf16 v[156:159], v[72:75], v[100:103], v[156:159]
  ds_write_b128 v6, v[216:219]
  v_mfma_f32_16x16x32_bf16 v[160:163], v[76:79], v[100:103], v[160:163]
  v_mfma_f32_16x16x32_bf16 v[164:167], v[80:83], v[100:103], v[164:167]
  v_cmp_gt_u32 vcc, 144, v0
  s_and_saveexec_b64 s[54:55], vcc
  ds_write_b128 v6, v[216:219] offset:4096
  s_mov_b64 exec, s[54:55]
  v_mfma_f32_16x16x32_bf16 v[168:171], v[84:87], v[100:103], v[168:171]
  s_nop 5
  v_pk_fma_f32 v[2:3], v[108:109], s[50:51], v[34:35]
  v_pk_fma_f32 v[4:5], v[110:111], s[50:51], v[34:35]
  v_exp_f32_e64 v2, v2 clamp
  v_exp_f32_e64 v3, v3 clamp
  v_exp_f32_e64 v4, v4 clamp
  v_exp_f32_e64 v5, v5 clamp
  v_pk_fma_f32 v[216:217], v[112:113], s[50:51], v[34:35]
  v_pk_fma_f32 v[218:219], v[114:115], s[50:51], v[34:35]
  v_exp_f32_e64 v216, v216 clamp
  v_max_f32 v108, v108, v2
  v_exp_f32_e64 v217, v217 clamp
  v_max_f32 v109, v109, v3
  v_exp_f32_e64 v218, v218 clamp
  v_max_f32 v110, v110, v4
  v_exp_f32_e64 v219, v219 clamp
  v_max_f32 v111, v111, v5
  v_pk_add_f32 v[108:109], v[108:109], s[52:53]
  v_pk_add_f32 v[110:111], v[110:111], s[52:53]
  v_cvt_pk_bf16_f32 v180, v108, v109
  v_cvt_pk_bf16_f32 v181, v110, v111
  v_pk_fma_f32 v[2:3], v[116:117], s[50:51], v[34:35]
  v_pk_fma_f32 v[4:5], v[118:119], s[50:51], v[34:35]
  v_exp_f32_e64 v2, v2 clamp
  v_max_f32 v112, v112, v216
  v_exp_f32_e64 v3, v3 clamp
  v_max_f32 v113, v113, v217
  v_exp_f32_e64 v4, v4 clamp
  v_max_f32 v114, v114, v218
  v_exp_f32_e64 v5, v5 clamp
  v_max_f32 v115, v115, v219
  v_pk_add_f32 v[112:113], v[112:113], s[52:53]
  v_pk_add_f32 v[114:115], v[114:115], s[52:53]
  v_cvt_pk_bf16_f32 v182, v112, v113
  v_cvt_pk_bf16_f32 v183, v114, v115
  ds_write_b128 v22, v[180:183] offset:0
  v_pk_fma_f32 v[216:217], v[120:121], s[50:51], v[34:35]
  v_pk_fma_f32 v[218:219], v[122:123], s[50:51], v[34:35]
  v_exp_f32_e64 v216, v216 clamp
  v_max_f32 v116, v116, v2
  v_exp_f32_e64 v217, v217 clamp
  v_max_f32 v117, v117, v3
  v_exp_f32_e64 v218, v218 clamp
  v_max_f32 v118, v118, v4
  v_exp_f32_e64 v219, v219 clamp
  v_max_f32 v119, v119, v5
  v_pk_add_f32 v[116:117], v[116:117], s[52:53]
  v_pk_add_f32 v[118:119], v[118:119], s[52:53]
  v_cvt_pk_bf16_f32 v184, v116, v117
  v_cvt_pk_bf16_f32 v185, v118, v119
  v_cvt_pk_bf16_f32 v196, v140, v141
  v_cvt_pk_bf16_f32 v197, v142, v143
  v_cvt_pk_bf16_f32 v198, v144, v145
  v_cvt_pk_bf16_f32 v199, v146, v147
  ds_write_b128 v22, v[196:199] offset:16384
  v_pk_fma_f32 v[2:3], v[124:125], s[50:51], v[34:35]
  v_pk_fma_f32 v[4:5], v[126:127], s[50:51], v[34:35]
  v_exp_f32_e64 v2, v2 clamp
  v_max_f32 v120, v120, v216
  v_exp_f32_e64 v3, v3 clamp
  v_max_f32 v121, v121, v217
  v_exp_f32_e64 v4, v4 clamp
  v_max_f32 v122, v122, v218
  v_exp_f32_e64 v5, v5 clamp
  v_max_f32 v123, v123, v219
  v_pk_add_f32 v[120:121], v[120:121], s[52:53]
  v_pk_add_f32 v[122:123], v[122:123], s[52:53]
  v_cvt_pk_bf16_f32 v186, v120, v121
  v_cvt_pk_bf16_f32 v187, v122, v123
  ds_write_b128 v23, v[184:187] offset:0
  v_cvt_pk_bf16_f32 v200, v148, v149
  v_cvt_pk_bf16_f32 v201, v150, v151
  v_cvt_pk_bf16_f32 v202, v152, v153
  v_cvt_pk_bf16_f32 v203, v154, v155
  ds_write_b128 v23, v[200:203] offset:16384
  v_pk_fma_f32 v[216:217], v[128:129], s[50:51], v[34:35]
  v_pk_fma_f32 v[218:219], v[130:131], s[50:51], v[34:35]
  v_exp_f32_e64 v216, v216 clamp
  v_max_f32 v124, v124, v2
  v_exp_f32_e64 v217, v217 clamp
  v_max_f32 v125, v125, v3
  v_exp_f32_e64 v218, v218 clamp
  v_max_f32 v126, v126, v4
  v_exp_f32_e64 v219, v219 clamp
  v_max_f32 v127, v127, v5
  v_pk_add_f32 v[124:125], v[124:125], s[52:53]
  v_pk_add_f32 v[126:127], v[126:127], s[52:53]
  v_cvt_pk_bf16_f32 v188, v124, v125
  v_cvt_pk_bf16_f32 v189, v126, v127
  v_cvt_pk_bf16_f32 v204, v156, v157
  v_cvt_pk_bf16_f32 v205, v158, v159
  v_cvt_pk_bf16_f32 v206, v160, v161
  v_cvt_pk_bf16_f32 v207, v162, v163
  ds_write_b128 v22, v[204:207] offset:20480
  v_pk_fma_f32 v[2:3], v[132:133], s[50:51], v[34:35]
  v_pk_fma_f32 v[4:5], v[134:135], s[50:51], v[34:35]
  v_exp_f32_e64 v2, v2 clamp
  v_max_f32 v128, v128, v216
  v_exp_f32_e64 v3, v3 clamp
  v_max_f32 v129, v129, v217
  v_exp_f32_e64 v4, v4 clamp
  v_max_f32 v130, v130, v218
  v_exp_f32_e64 v5, v5 clamp
  v_max_f32 v131, v131, v219
  v_pk_add_f32 v[128:129], v[128:129], s[52:53]
  v_pk_add_f32 v[130:131], v[130:131], s[52:53]
  v_cvt_pk_bf16_f32 v190, v128, v129
  v_cvt_pk_bf16_f32 v191, v130, v131
  ds_write_b128 v22, v[188:191] offset:4096
  v_cvt_pk_bf16_f32 v208, v164, v165
  v_cvt_pk_bf16_f32 v209, v166, v167
  v_cvt_pk_bf16_f32 v210, v168, v169
  v_cvt_pk_bf16_f32 v211, v170, v171
  ds_write_b128 v23, v[208:211] offset:20480
  v_pk_fma_f32 v[216:217], v[136:137], s[50:51], v[34:35]
  v_pk_fma_f32 v[218:219], v[138:139], s[50:51], v[34:35]
  v_exp_f32_e64 v216, v216 clamp
  v_max_f32 v132, v132, v2
  v_exp_f32_e64 v217, v217 clamp
  v_max_f32 v133, v133, v3
  v_exp_f32_e64 v218, v218 clamp
  v_max_f32 v134, v134, v4
  v_exp_f32_e64 v219, v219 clamp
  v_max_f32 v135, v135, v5
  v_pk_add_f32 v[132:133], v[132:133], s[52:53]
  v_pk_add_f32 v[134:135], v[134:135], s[52:53]
  v_cvt_pk_bf16_f32 v192, v132, v133
  v_cvt_pk_bf16_f32 v193, v134, v135
  v_max_f32 v136, v136, v216
  v_max_f32 v137, v137, v217
  v_max_f32 v138, v138, v218
  v_max_f32 v139, v139, v219
  v_pk_add_f32 v[136:137], v[136:137], s[52:53]
  v_pk_add_f32 v[138:139], v[138:139], s[52:53]
  v_cvt_pk_bf16_f32 v194, v136, v137
  v_cvt_pk_bf16_f32 v195, v138, v139
  ds_write_b128 v23, v[192:195] offset:4096
  v_cmp_gt_u32 s[56:57], 8, v8
  s_mov_b64 s[54:55], exec
  s_mov_b64 exec, s[56:57]
  v_pk_fma_f32 v[2:3], v[172:173], s[50:51], v[34:35]
  v_pk_fma_f32 v[4:5], v[174:175], s[50:51], v[34:35]
  v_exp_f32_e64 v2, v2 clamp
  v_exp_f32_e64 v4, v4 clamp
  v_exp_f32_e64 v3, v3 clamp
  v_exp_f32_e64 v5, v5 clamp
  v_max_f32 v172, v172, v2
  v_max_f32 v173, v173, v3
  v_max_f32 v174, v174, v4
  v_max_f32 v175, v175, v5
  v_pk_add_f32 v[172:173], v[172:173], s[52:53]
  v_pk_add_f32 v[174:175], v[174:175], s[52:53]
  v_pk_fma_f32 v[2:3], v[176:177], s[50:51], v[34:35]
  v_pk_fma_f32 v[4:5], v[178:179], s[50:51], v[34:35]
  v_exp_f32_e64 v2, v2 clamp
  v_exp_f32_e64 v4, v4 clamp
  v_exp_f32_e64 v3, v3 clamp
  v_exp_f32_e64 v5, v5 clamp
  v_max_f32 v176, v176, v2
  v_max_f32 v177, v177, v3
  v_max_f32 v178, v178, v4
  v_max_f32 v179, v179, v5
  v_pk_add_f32 v[176:177], v[176:177], s[52:53]
  v_pk_add_f32 v[178:179], v[178:179], s[52:53]
  s_mov_b64 exec, s[54:55]
  v_cvt_pk_bf16_f32 v212, v172, v173
  v_cvt_pk_bf16_f32 v213, v174, v175
  v_cvt_pk_bf16_f32 v214, v176, v177
  v_cvt_pk_bf16_f32 v215, v178, v179
  ds_write_b128 v24, v[212:215] offset:32768
  v_mov_b32 v220, 0x3f803f80
  v_mov_b32 v221, 0x3f803f80
  v_mov_b32 v222, 0x3f803f80
  v_mov_b32 v223, 0x3f803f80
  s_mov_b32 s35, 0
standalone__linear_attn_block__prompt_kernel_poll:
  s_waitcnt vmcnt(0)
  v_cmp_ne_u32 vcc, 1, v254
  s_nop 4
  s_cmp_eq_u64 vcc, 0
  s_cbranch_scc1 standalone__linear_attn_block__prompt_kernel_go
  s_add_u32 s35, s35, 1
  s_cmp_gt_u32 s35, 20000
  s_cbranch_scc1 standalone__linear_attn_block__prompt_kernel_go
  global_load_dword v254, v32, s[76:77] sc1
  s_branch standalone__linear_attn_block__prompt_kernel_poll
standalone__linear_attn_block__prompt_kernel_go:
  s_waitcnt lgkmcnt(0)
  s_barrier
  s_lshl_b32 s29, s24, 12
  v_add_u32 v6, s29, v7
  ds_read_b128 v[36:39], v6 offset:0
  ds_read_b128 v[52:55], v6 offset:16384
  ds_read_b128 v[68:71], v7 offset:32768
  ds_read_b128 v[40:43], v6 offset:1024
  ds_read_b128 v[56:59], v6 offset:17408
  ds_read_b128 v[72:75], v7 offset:33792
  ds_read_b128 v[44:47], v6 offset:2048
  ds_read_b128 v[60:63], v6 offset:18432
  ds_read_b128 v[76:79], v7 offset:34816
  ds_read_b128 v[48:51], v6 offset:3072
  ds_read_b128 v[64:67], v6 offset:19456
  ds_read_b128 v[80:83], v7 offset:35840
  s_mul_i32 s30, s24, 1600
  s_add_u32 s30, s30, 36864
  s_and_b32 s62, s24, 1
  s_lshr_b32 s31, s24, 1
  s_lshl_b32 s29, s31, 2
  s_lshl_b32 s63, s62, 1
  s_add_u32 s29, s29, s63
  s_add_u32 s29, s29, 8
  v_subrev_u32 v5, s29, v8
  v_cmp_gt_u32 s[56:57], 2, v5
  v_cmp_eq_u32 s[58:59], 0, v8
  v_add_u32 v5, 16, v5
  v_mov_b32 v4, 18
  v_cndmask_b32 v5, v5, v4, s[58:59]
  s_or_b64 s[56:57], s[56:57], s[58:59]
  s_waitcnt lgkmcnt(9)
  v_mfma_f32_16x16x32_bf16 v[108:111], v[36:39], v[52:55], 0
  v_cndmask_b32 v84, v68, v220, s[58:59]
  v_cndmask_b32 v85, v69, v221, s[58:59]
  v_cndmask_b32 v86, v70, v222, s[58:59]
  v_cndmask_b32 v87, v71, v223, s[58:59]
  v_mfma_f32_16x16x32_bf16 v[116:119], v[68:71], v[52:55], 0
  s_lshl_b32 s63, s62, 4
  s_add_u32 s63, s63, s30
  v_lshlrev_b32 v6, 4, v9
  v_add_u32 v6, s63, v6
  v_mfma_f32_16x16x32_bf16 v[112:115], v[36:39], v[84:87], 0
  v_mul_u32_u24 v2, 80, v8
  v_mul_u32_u24 v3, 80, v5
  v_mfma_f32_16x16x32_bf16 v[120:123], v[68:71], v[84:87], 0
  s_waitcnt lgkmcnt(6)
  v_mfma_f32_16x16x32_bf16 v[108:111], v[40:43], v[56:59], v[108:111]
  v_cndmask_b32 v88, v72, v220, s[58:59]
  v_cndmask_b32 v89, v73, v221, s[58:59]
  v_cndmask_b32 v90, v74, v222, s[58:59]
  v_cndmask_b32 v91, v75, v223, s[58:59]
  v_mfma_f32_16x16x32_bf16 v[116:119], v[72:75], v[56:59], v[116:119]
  v_add_u32 v26, v2, v6
  v_add_u32 v27, v3, v6
  v_mfma_f32_16x16x32_bf16 v[112:115], v[40:43], v[88:91], v[112:115]
  s_cmp_eq_u32 s62, 0
  s_cselect_b32 s63, 64, 8
  s_add_u32 s63, s63, s30
  v_mfma_f32_16x16x32_bf16 v[120:123], v[72:75], v[88:91], v[120:123]
  s_waitcnt lgkmcnt(3)
  v_mfma_f32_16x16x32_bf16 v[108:111], v[44:47], v[60:63], v[108:111]
  v_cndmask_b32 v92, v76, v220, s[58:59]
  v_cndmask_b32 v93, v77, v221, s[58:59]
  v_cndmask_b32 v94, v78, v222, s[58:59]
  v_cndmask_b32 v95, v79, v223, s[58:59]
  v_mfma_f32_16x16x32_bf16 v[116:119], v[76:79], v[60:63], v[116:119]
  v_add_u32 v28, s63, v2
  v_add_u32 v29, s63, v3
  v_mfma_f32_16x16x32_bf16 v[112:115], v[44:47], v[92:95], v[112:115]
  v_cmp_eq_u32 vcc, s31, v9
  v_mfma_f32_16x16x32_bf16 v[120:123], v[76:79], v[92:95], v[120:123]
  s_waitcnt lgkmcnt(0)
  v_mfma_f32_16x16x32_bf16 v[108:111], v[48:51], v[64:67], v[108:111]
  v_cndmask_b32 v96, v80, v220, s[58:59]
  v_cndmask_b32 v97, v81, v221, s[58:59]
  v_cndmask_b32 v98, v82, v222, s[58:59]
  v_cndmask_b32 v99, v83, v223, s[58:59]
  v_mfma_f32_16x16x32_bf16 v[116:119], v[80:83], v[64:67], v[116:119]
  s_lshl_b32 s29, s28, 2
  s_add_u32 s29, s29, s24
  s_mul_i32 s29, s29, 1600
  s_add_u32 s29, s29, 2359296
  v_lshlrev_b32 v22, 2, v1
  v_mfma_f32_16x16x32_bf16 v[112:115], v[48:51], v[96:99], v[112:115]
  v_add_u32 v23, s29, v22
  v_add_u32 v22, s30, v22
  v_mfma_f32_16x16x32_bf16 v[120:123], v[80:83], v[96:99], v[120:123]
  s_nop 5
  ds_write_b128 v26, v[108:111]
  s_mov_b64 s[54:55], exec
  s_mov_b64 exec, s[56:57]
  ds_write_b128 v27, v[112:115]
  s_mov_b64 exec, s[54:55]
  s_cmp_eq_u32 s62, 0
  s_cbranch_scc1 standalone__linear_attn_block__prompt_kernel_xe
  v_mov_b32 v116, v118
  v_mov_b32 v117, v119
  v_mov_b32 v120, v122
  v_mov_b32 v121, v123
standalone__linear_attn_block__prompt_kernel_xe:
  s_and_b64 s[56:57], s[56:57], vcc
  s_mov_b64 exec, vcc
  ds_write_b64 v28, v[116:117]
  s_mov_b64 exec, s[56:57]
  ds_write_b64 v29, v[120:121]
  s_mov_b64 exec, s[54:55]
  s_waitcnt lgkmcnt(0)
  ds_read_b32 v180, v22 offset:0
  ds_read_b32 v181, v22 offset:256
  ds_read_b32 v182, v22 offset:512
  ds_read_b32 v183, v22 offset:768
  ds_read_b32 v184, v22 offset:1024
  ds_read_b32 v185, v22 offset:1280
  ds_read_b32 v186, v22 offset:1536
  v_cmp_gt_u32 vcc, 16, v1
  s_mov_b64 s[56:57], vcc
  s_waitcnt lgkmcnt(0)
  global_atomic_add_f32 v23, v180, s[78:79] offset:0
  global_atomic_add_f32 v23, v181, s[78:79] offset:256
  global_atomic_add_f32 v23, v182, s[78:79] offset:512
  global_atomic_add_f32 v23, v183, s[78:79] offset:768
  global_atomic_add_f32 v23, v184, s[78:79] offset:1024
  global_atomic_add_f32 v23, v185, s[78:79] offset:1280
  s_mov_b64 s[54:55], exec
  s_mov_b64 exec, s[56:57]
  global_atomic_add_f32 v23, v186, s[78:79] offset:1536
  s_mov_b64 exec, s[54:55]
  s_lshl_b32 s3, s28, 7
  s_add_u32 s3, s3, 2410496
  s_mov_b32 s4, 8
  s_lshr_b32 s30, s64, 1
  s_lshl_b32 s30, s30, 7
  s_add_u32 s30, s30, 2418688
  v_mov_b32 v219, s30
  global_load_dword v218, v219, s[78:79] sc1
  s_lshl_b32 s29, s64, 2
  s_lshl_b32 s30, s34, 1
  s_add_u32 s29, s29, s30
  s_mul_i32 s29, s29, 18432
  s_lshl_b32 s30, s33, 13
  s_add_u32 s30, s30, s29
  v_lshlrev_b32 v246, 4, v1
  v_add_u32 v246, s30, v246
  s_lshl_b32 s30, s33, 10
  s_add_u32 s30, s30, s29
  s_add_u32 s30, s30, 16384
  v_lshlrev_b32 v247, 3, v1
  v_add_u32 v247, s30, v247
  v_and_b32 v2, 127, v0
  s_mul_i32 s30, s33, 1600
  v_add_u32 v2, s30, v2
  v_lshlrev_b32 v248, 4, v2
  v_add_u32 v248, 2359296, v248
  v_lshlrev_b32 v249, 3, v2
  v_add_u32 v249, 0, v249
  s_mul_i32 s29, s33, 55296
  s_add_u32 s29, s29, 53248
  v_lshl_add_u32 v2, v9, 2, v10
  v_mul_u32_u24 v2, 192, v2
  v_lshl_add_u32 v2, v11, 3, v2
  v_add_u32 v2, s29, v2
  v_and_b32 v3, 1, v9
  v_lshl_add_u32 v227, v3, 5, v2
  v_xor_b32 v3, 1, v3
  v_lshl_add_u32 v228, v3, 5, v2
  v_mul_u32_u24 v2, 36, v10
  v_add3_u32 v2, v2, v9, 16
  v_mul_u32_u24 v2, 192, v2
  v_lshl_add_u32 v2, v11, 3, v2
  v_add_u32 v2, s29, v2
  v_and_b32 v3, 1, v10
  v_lshl_add_u32 v229, v3, 5, v2
  v_xor_b32 v3, 1, v3
  v_lshl_add_u32 v230, v3, 5, v2
  v_mov_b32 v152, 0
  v_mov_b32 v153, 0x358637bd
  v_mov_b32 v154, 0x358637bd
  v_mov_b32 v155, 0
  s_mov_b32 m0, s65
  s_add_u32 s65, s65, 12288
  buffer_load_dwordx4 v224, s[80:83], s66 offen lds
  buffer_load_dwordx4 v225, s[80:83], s66 offen offset:1024 lds
  buffer_load_dwordx4 v226, s[80:83], s66 offen offset:2048 lds
  s_add_u32 s66, s66, 73728
  s_mov_b32 m0, s65
  s_add_u32 s65, s65, 12288
  buffer_load_dwordx4 v224, s[80:83], s66 offen lds
  buffer_load_dwordx4 v225, s[80:83], s66 offen offset:1024 lds
  buffer_load_dwordx4 v226, s[80:83], s66 offen offset:2048 lds
  s_add_u32 s66, s66, 73728
  s_mov_b32 m0, s65
  s_add_u32 s65, s65, 12288
  buffer_load_dwordx4 v224, s[80:83], s66 offen lds
  buffer_load_dwordx4 v225, s[80:83], s66 offen offset:1024 lds
  buffer_load_dwordx4 v226, s[80:83], s66 offen offset:2048 lds
  s_add_u32 s66, s66, 73728
  s_waitcnt vmcnt(9)
  s_barrier
  s_cmp_eq_u32 s24, 0
  s_cbranch_scc0 standalone__linear_attn_block__prompt_kernel_ksig1
  v_lshlrev_b32 v2, 10, v1
  v_add_u32 v2, s3, v2
  v_mov_b32 v3, 1
  v_cmp_gt_u32 vcc, 8, v1
  s_and_saveexec_b64 s[54:55], vcc
  global_atomic_add v2, v3, s[78:79] sc1
  s_mov_b64 exec, s[54:55]
standalone__linear_attn_block__prompt_kernel_ksig1:
  s_branch standalone__linear_attn_block__prompt_kernel_p2
standalone__linear_attn_block__prompt_kernel_q:
  s_waitcnt vmcnt(10)
  s_barrier
  ds_read_b128 v[36:39], v22 offset:0
  ds_read_b64_tr_b16 v[52:53], v26 offset:0
  ds_read_b64_tr_b16 v[54:55], v26 offset:1536
  ds_read_b128 v[40:43], v22 offset:2048
  ds_read_b128 v[44:47], v23 offset:0
  ds_read_b128 v[48:51], v23 offset:2048
  ds_read_b64_tr_b16 v[56:57], v27 offset:0
  ds_read_b64_tr_b16 v[58:59], v27 offset:1536
  ds_read_b64_tr_b16 v[60:61], v28 offset:0
  ds_read_b64_tr_b16 v[62:63], v28 offset:1536
  ds_read_b64_tr_b16 v[64:65], v29 offset:0
  ds_read_b64_tr_b16 v[66:67], v29 offset:1536
  ds_read_b64_tr_b16 v[68:69], v30 offset:0
  ds_read_b64_tr_b16 v[70:71], v30 offset:1536
  s_mov_b32 s35, 0
  s_waitcnt lgkmcnt(11)
  v_mfma_f32_16x16x32_bf16 v[108:111], v[52:55], v[36:39], 1.0
  ds_read_b128 v[72:75], v24 offset:0
  ds_read_b64_tr_b16 v[88:89], v26 offset:12288
  s_waitcnt lgkmcnt(12)
  v_mfma_f32_16x16x32_bf16 v[112:115], v[52:55], v[40:43], 1.0
  ds_read_b64_tr_b16 v[90:91], v26 offset:13824
  s_add_u32 m0, s36, 32768
  s_mul_i32 s40, s39, 1728
  s_waitcnt lgkmcnt(12)
  v_mfma_f32_16x16x32_bf16 v[116:119], v[52:55], v[44:47], 1.0
  ds_read_b128 v[76:79], v24 offset:2048
  buffer_load_dwordx4 v12, s[8:11], s39 offen offset:0 lds
  s_waitcnt lgkmcnt(12)
  v_mfma_f32_16x16x32_bf16 v[120:123], v[52:55], v[48:51], 1.0
  ds_read_b128 v[80:83], v25 offset:0
  buffer_load_dwordx4 v13, s[8:11], s39 offen offset:1024 lds
  s_waitcnt lgkmcnt(11)
  v_mfma_f32_16x16x32_bf16 v[124:127], v[56:59], v[36:39], 1.0
  ds_read_b128 v[84:87], v25 offset:2048
  buffer_load_dwordx4 v14, s[8:11], s39 offen offset:2048 lds
  v_mfma_f32_16x16x32_bf16 v[128:131], v[56:59], v[40:43], 1.0
  ds_read_b64_tr_b16 v[92:93], v27 offset:12288
  buffer_load_dwordx4 v15, s[8:11], s39 offen offset:3072 lds
  v_mfma_f32_16x16x32_bf16 v[132:135], v[56:59], v[44:47], 1.0
  ds_read_b64_tr_b16 v[94:95], v27 offset:13824
  ds_read_b64_tr_b16 v[96:97], v28 offset:12288
  v_mfma_f32_16x16x32_bf16 v[136:139], v[56:59], v[48:51], 1.0
  ds_read_b64_tr_b16 v[98:99], v28 offset:13824
  s_add_u32 m0, s37, 49152
  s_add_u32 s39, s39, 128
  s_waitcnt lgkmcnt(14)
  v_mfma_f32_16x16x32_bf16 v[140:143], v[60:63], v[36:39], 1.0
  ds_read_b64_tr_b16 v[100:101], v29 offset:12288
  buffer_load_dwordx4 v16, s[12:15], s40 offen offset:0 lds
  v_mfma_f32_16x16x32_bf16 v[144:147], v[60:63], v[40:43], 1.0
  ds_read_b64_tr_b16 v[102:103], v29 offset:13824
  buffer_load_dwordx4 v17, s[12:15], s40 offen offset:1024 lds
  v_mfma_f32_16x16x32_bf16 v[148:151], v[60:63], v[44:47], 1.0
  ds_read_b64_tr_b16 v[104:105], v30 offset:12288
  buffer_load_dwordx4 v18, s[12:15], s40 offen offset:2048 lds
  v_mfma_f32_16x16x32_bf16 v[152:155], v[60:63], v[48:51], 1.0
  ds_read_b64_tr_b16 v[106:107], v30 offset:13824
  s_waitcnt lgkmcnt(15)
  v_mfma_f32_16x16x32_bf16 v[156:159], v[64:67], v[36:39], 1.0
  buffer_load_dwordx4 v19, s[12:15], s40 offen offset:3072 lds
  v_mfma_f32_16x16x32_bf16 v[160:163], v[64:67], v[40:43], 1.0
  s_add_u32 m0, s37, 53248
  s_nop 0
  v_mfma_f32_16x16x32_bf16 v[164:167], v[64:67], v[44:47], 1.0
  buffer_load_dwordx4 v20, s[12:15], s40 offen offset:0 lds
  v_mfma_f32_16x16x32_bf16 v[168:171], v[64:67], v[48:51], 1.0
  buffer_load_dwordx4 v21, s[12:15], s40 offen offset:1024 lds
  s_waitcnt lgkmcnt(14)
  v_mfma_f32_16x16x32_bf16 v[172:175], v[68:71], v[36:39], 1.0
  v_mfma_f32_16x16x32_bf16 v[176:179], v[68:71], v[40:43], 1.0
standalone__linear_attn_block__prompt_kernel_qq_loop:
  s_waitcnt lgkmcnt(11)
  v_mfma_f32_16x16x32_bf16 v[108:111], v[88:91], v[72:75], v[108:111]
  s_waitcnt lgkmcnt(10)
  v_mfma_f32_16x16x32_bf16 v[112:115], v[88:91], v[76:79], v[112:115]
  s_waitcnt vmcnt(10) lgkmcnt(0)
  s_barrier
  v_mfma_f32_16x16x32_bf16 v[116:119], v[88:91], v[80:83], v[116:119]
  ds_read_b128 v[36:39], v22 offset:16384
  ds_read_b64_tr_b16 v[52:53], v26 offset:24576
  v_mfma_f32_16x16x32_bf16 v[120:123], v[88:91], v[84:87], v[120:123]
  ds_read_b64_tr_b16 v[54:55], v26 offset:26112
  s_add_u32 m0, s36, 0
  s_mul_i32 s40, s39, 1728
  v_mfma_f32_16x16x32_bf16 v[124:127], v[92:95], v[72:75], v[124:127]
  ds_read_b128 v[40:43], v22 offset:18432
  v_mfma_f32_16x16x32_bf16 v[128:131], v[92:95], v[76:79], v[128:131]
  ds_read_b128 v[44:47], v23 offset:16384
  v_mfma_f32_16x16x32_bf16 v[132:135], v[92:95], v[80:83], v[132:135]
  ds_read_b128 v[48:51], v23 offset:18432
  buffer_load_dwordx4 v12, s[8:11], s39 offen offset:0 lds
  v_mfma_f32_16x16x32_bf16 v[136:139], v[92:95], v[84:87], v[136:139]
  ds_read_b64_tr_b16 v[56:57], v27 offset:24576
  v_mfma_f32_16x16x32_bf16 v[140:143], v[96:99], v[72:75], v[140:143]
  ds_read_b64_tr_b16 v[58:59], v27 offset:26112
  ds_read_b64_tr_b16 v[60:61], v28 offset:24576
  v_mfma_f32_16x16x32_bf16 v[144:147], v[96:99], v[76:79], v[144:147]
  ds_read_b64_tr_b16 v[62:63], v28 offset:26112
  buffer_load_dwordx4 v13, s[8:11], s39 offen offset:1024 lds
  v_mfma_f32_16x16x32_bf16 v[148:151], v[96:99], v[80:83], v[148:151]
  ds_read_b64_tr_b16 v[64:65], v29 offset:24576
  v_mfma_f32_16x16x32_bf16 v[152:155], v[96:99], v[84:87], v[152:155]
  ds_read_b64_tr_b16 v[66:67], v29 offset:26112
  v_mfma_f32_16x16x32_bf16 v[156:159], v[100:103], v[72:75], v[156:159]
  ds_read_b64_tr_b16 v[68:69], v30 offset:24576
  buffer_load_dwordx4 v14, s[8:11], s39 offen offset:2048 lds
  v_mfma_f32_16x16x32_bf16 v[160:163], v[100:103], v[76:79], v[160:163]
  ds_read_b64_tr_b16 v[70:71], v30 offset:26112
  v_mfma_f32_16x16x32_bf16 v[164:167], v[100:103], v[80:83], v[164:167]
  v_mfma_f32_16x16x32_bf16 v[168:171], v[100:103], v[84:87], v[168:171]
  buffer_load_dwordx4 v15, s[8:11], s39 offen offset:3072 lds
  v_mfma_f32_16x16x32_bf16 v[172:175], v[104:107], v[72:75], v[172:175]
  v_mfma_f32_16x16x32_bf16 v[176:179], v[104:107], v[76:79], v[176:179]
  s_waitcnt lgkmcnt(11)
  v_mfma_f32_16x16x32_bf16 v[108:111], v[52:55], v[36:39], v[108:111]
  ds_read_b128 v[72:75], v24 offset:16384
  ds_read_b64_tr_b16 v[88:89], v26 offset:36864
  s_waitcnt lgkmcnt(12)
  v_mfma_f32_16x16x32_bf16 v[112:115], v[52:55], v[40:43], v[112:115]
  ds_read_b64_tr_b16 v[90:91], v26 offset:38400
  s_add_u32 m0, s37, 0
  s_add_u32 s39, s39, 128
  s_waitcnt lgkmcnt(12)
  v_mfma_f32_16x16x32_bf16 v[116:119], v[52:55], v[44:47], v[116:119]
  ds_read_b128 v[76:79], v24 offset:18432
  s_waitcnt lgkmcnt(12)
  v_mfma_f32_16x16x32_bf16 v[120:123], v[52:55], v[48:51], v[120:123]
  ds_read_b128 v[80:83], v25 offset:16384
  buffer_load_dwordx4 v16, s[12:15], s40 offen offset:0 lds
  s_waitcnt lgkmcnt(11)
  v_mfma_f32_16x16x32_bf16 v[124:127], v[56:59], v[36:39], v[124:127]
  ds_read_b128 v[84:87], v25 offset:18432
  v_mfma_f32_16x16x32_bf16 v[128:131], v[56:59], v[40:43], v[128:131]
  ds_read_b64_tr_b16 v[92:93], v27 offset:36864
  buffer_load_dwordx4 v17, s[12:15], s40 offen offset:1024 lds
  v_mfma_f32_16x16x32_bf16 v[132:135], v[56:59], v[44:47], v[132:135]
  ds_read_b64_tr_b16 v[94:95], v27 offset:38400
  ds_read_b64_tr_b16 v[96:97], v28 offset:36864
  v_mfma_f32_16x16x32_bf16 v[136:139], v[56:59], v[48:51], v[136:139]
  ds_read_b64_tr_b16 v[98:99], v28 offset:38400
  buffer_load_dwordx4 v18, s[12:15], s40 offen offset:2048 lds
  s_waitcnt lgkmcnt(14)
  v_mfma_f32_16x16x32_bf16 v[140:143], v[60:63], v[36:39], v[140:143]
  ds_read_b64_tr_b16 v[100:101], v29 offset:36864
  v_mfma_f32_16x16x32_bf16 v[144:147], v[60:63], v[40:43], v[144:147]
  ds_read_b64_tr_b16 v[102:103], v29 offset:38400
  buffer_load_dwordx4 v19, s[12:15], s40 offen offset:3072 lds
  v_mfma_f32_16x16x32_bf16 v[148:151], v[60:63], v[44:47], v[148:151]
  ds_read_b64_tr_b16 v[104:105], v30 offset:36864
  v_mfma_f32_16x16x32_bf16 v[152:155], v[60:63], v[48:51], v[152:155]
  ds_read_b64_tr_b16 v[106:107], v30 offset:38400
  s_add_u32 m0, s37, 4096
  s_nop 0
  s_waitcnt lgkmcnt(15)
  v_mfma_f32_16x16x32_bf16 v[156:159], v[64:67], v[36:39], v[156:159]
  v_mfma_f32_16x16x32_bf16 v[160:163], v[64:67], v[40:43], v[160:163]
  buffer_load_dwordx4 v20, s[12:15], s40 offen offset:0 lds
  v_mfma_f32_16x16x32_bf16 v[164:167], v[64:67], v[44:47], v[164:167]
  v_mfma_f32_16x16x32_bf16 v[168:171], v[64:67], v[48:51], v[168:171]
  buffer_load_dwordx4 v21, s[12:15], s40 offen offset:1024 lds
  s_waitcnt lgkmcnt(14)
  v_mfma_f32_16x16x32_bf16 v[172:175], v[68:71], v[36:39], v[172:175]
  v_mfma_f32_16x16x32_bf16 v[176:179], v[68:71], v[40:43], v[176:179]
  s_waitcnt lgkmcnt(11)
  v_mfma_f32_16x16x32_bf16 v[108:111], v[88:91], v[72:75], v[108:111]
  s_waitcnt lgkmcnt(10)
  v_mfma_f32_16x16x32_bf16 v[112:115], v[88:91], v[76:79], v[112:115]
  s_waitcnt vmcnt(10) lgkmcnt(0)
  s_barrier
  v_mfma_f32_16x16x32_bf16 v[116:119], v[88:91], v[80:83], v[116:119]
  ds_read_b128 v[36:39], v22 offset:32768
  ds_read_b64_tr_b16 v[52:53], v26 offset:49152
  v_mfma_f32_16x16x32_bf16 v[120:123], v[88:91], v[84:87], v[120:123]
  ds_read_b64_tr_b16 v[54:55], v26 offset:50688
  s_add_u32 m0, s36, 16384
  s_mul_i32 s40, s39, 1728
  v_mfma_f32_16x16x32_bf16 v[124:127], v[92:95], v[72:75], v[124:127]
  ds_read_b128 v[40:43], v22 offset:34816
  v_mfma_f32_16x16x32_bf16 v[128:131], v[92:95], v[76:79], v[128:131]
  ds_read_b128 v[44:47], v23 offset:32768
  v_mfma_f32_16x16x32_bf16 v[132:135], v[92:95], v[80:83], v[132:135]
  ds_read_b128 v[48:51], v23 offset:34816
  buffer_load_dwordx4 v12, s[8:11], s39 offen offset:0 lds
  v_mfma_f32_16x16x32_bf16 v[136:139], v[92:95], v[84:87], v[136:139]
  ds_read_b64_tr_b16 v[56:57], v27 offset:49152
  v_mfma_f32_16x16x32_bf16 v[140:143], v[96:99], v[72:75], v[140:143]
  ds_read_b64_tr_b16 v[58:59], v27 offset:50688
  ds_read_b64_tr_b16 v[60:61], v28 offset:49152
  v_mfma_f32_16x16x32_bf16 v[144:147], v[96:99], v[76:79], v[144:147]
  ds_read_b64_tr_b16 v[62:63], v28 offset:50688
  buffer_load_dwordx4 v13, s[8:11], s39 offen offset:1024 lds
  v_mfma_f32_16x16x32_bf16 v[148:151], v[96:99], v[80:83], v[148:151]
  ds_read_b64_tr_b16 v[64:65], v29 offset:49152
  v_mfma_f32_16x16x32_bf16 v[152:155], v[96:99], v[84:87], v[152:155]
  ds_read_b64_tr_b16 v[66:67], v29 offset:50688
  v_mfma_f32_16x16x32_bf16 v[156:159], v[100:103], v[72:75], v[156:159]
  ds_read_b64_tr_b16 v[68:69], v30 offset:49152
  buffer_load_dwordx4 v14, s[8:11], s39 offen offset:2048 lds
  v_mfma_f32_16x16x32_bf16 v[160:163], v[100:103], v[76:79], v[160:163]
  ds_read_b64_tr_b16 v[70:71], v30 offset:50688
  v_mfma_f32_16x16x32_bf16 v[164:167], v[100:103], v[80:83], v[164:167]
  v_mfma_f32_16x16x32_bf16 v[168:171], v[100:103], v[84:87], v[168:171]
  buffer_load_dwordx4 v15, s[8:11], s39 offen offset:3072 lds
  v_mfma_f32_16x16x32_bf16 v[172:175], v[104:107], v[72:75], v[172:175]
  v_mfma_f32_16x16x32_bf16 v[176:179], v[104:107], v[76:79], v[176:179]
  s_waitcnt lgkmcnt(11)
  v_mfma_f32_16x16x32_bf16 v[108:111], v[52:55], v[36:39], v[108:111]
  ds_read_b128 v[72:75], v24 offset:32768
  ds_read_b64_tr_b16 v[88:89], v26 offset:61440
  s_waitcnt lgkmcnt(12)
  v_mfma_f32_16x16x32_bf16 v[112:115], v[52:55], v[40:43], v[112:115]
  ds_read_b64_tr_b16 v[90:91], v26 offset:62976
  s_add_u32 m0, s37, 24576
  s_add_u32 s39, s39, 128
  s_waitcnt lgkmcnt(12)
  v_mfma_f32_16x16x32_bf16 v[116:119], v[52:55], v[44:47], v[116:119]
  ds_read_b128 v[76:79], v24 offset:34816
  s_waitcnt lgkmcnt(12)
  v_mfma_f32_16x16x32_bf16 v[120:123], v[52:55], v[48:51], v[120:123]
  ds_read_b128 v[80:83], v25 offset:32768
  buffer_load_dwordx4 v16, s[12:15], s40 offen offset:0 lds
  s_waitcnt lgkmcnt(11)
  v_mfma_f32_16x16x32_bf16 v[124:127], v[56:59], v[36:39], v[124:127]
  ds_read_b128 v[84:87], v25 offset:34816
  v_mfma_f32_16x16x32_bf16 v[128:131], v[56:59], v[40:43], v[128:131]
  ds_read_b64_tr_b16 v[92:93], v27 offset:61440
  buffer_load_dwordx4 v17, s[12:15], s40 offen offset:1024 lds
  v_mfma_f32_16x16x32_bf16 v[132:135], v[56:59], v[44:47], v[132:135]
  ds_read_b64_tr_b16 v[94:95], v27 offset:62976
  ds_read_b64_tr_b16 v[96:97], v28 offset:61440
  v_mfma_f32_16x16x32_bf16 v[136:139], v[56:59], v[48:51], v[136:139]
  ds_read_b64_tr_b16 v[98:99], v28 offset:62976
  buffer_load_dwordx4 v18, s[12:15], s40 offen offset:2048 lds
  s_waitcnt lgkmcnt(14)
  v_mfma_f32_16x16x32_bf16 v[140:143], v[60:63], v[36:39], v[140:143]
  ds_read_b64_tr_b16 v[100:101], v29 offset:61440
  v_mfma_f32_16x16x32_bf16 v[144:147], v[60:63], v[40:43], v[144:147]
  ds_read_b64_tr_b16 v[102:103], v29 offset:62976
  buffer_load_dwordx4 v19, s[12:15], s40 offen offset:3072 lds
  v_mfma_f32_16x16x32_bf16 v[148:151], v[60:63], v[44:47], v[148:151]
  ds_read_b64_tr_b16 v[104:105], v30 offset:61440
  v_mfma_f32_16x16x32_bf16 v[152:155], v[60:63], v[48:51], v[152:155]
  ds_read_b64_tr_b16 v[106:107], v30 offset:62976
  s_add_u32 m0, s37, 28672
  s_nop 0
  s_waitcnt lgkmcnt(15)
  v_mfma_f32_16x16x32_bf16 v[156:159], v[64:67], v[36:39], v[156:159]
  v_mfma_f32_16x16x32_bf16 v[160:163], v[64:67], v[40:43], v[160:163]
  buffer_load_dwordx4 v20, s[12:15], s40 offen offset:0 lds
  v_mfma_f32_16x16x32_bf16 v[164:167], v[64:67], v[44:47], v[164:167]
  v_mfma_f32_16x16x32_bf16 v[168:171], v[64:67], v[48:51], v[168:171]
  buffer_load_dwordx4 v21, s[12:15], s40 offen offset:1024 lds
  s_waitcnt lgkmcnt(14)
  v_mfma_f32_16x16x32_bf16 v[172:175], v[68:71], v[36:39], v[172:175]
  v_mfma_f32_16x16x32_bf16 v[176:179], v[68:71], v[40:43], v[176:179]
  s_waitcnt lgkmcnt(11)
  v_mfma_f32_16x16x32_bf16 v[108:111], v[88:91], v[72:75], v[108:111]
  s_waitcnt lgkmcnt(10)
  v_mfma_f32_16x16x32_bf16 v[112:115], v[88:91], v[76:79], v[112:115]
  s_waitcnt vmcnt(10) lgkmcnt(0)
  s_barrier
  v_mfma_f32_16x16x32_bf16 v[116:119], v[88:91], v[80:83], v[116:119]
  ds_read_b128 v[36:39], v22 offset:0
  ds_read_b64_tr_b16 v[52:53], v26 offset:0
  v_mfma_f32_16x16x32_bf16 v[120:123], v[88:91], v[84:87], v[120:123]
  ds_read_b64_tr_b16 v[54:55], v26 offset:1536
  s_add_u32 m0, s36, 32768
  s_mul_i32 s40, s39, 1728
  v_mfma_f32_16x16x32_bf16 v[124:127], v[92:95], v[72:75], v[124:127]
  ds_read_b128 v[40:43], v22 offset:2048
  v_mfma_f32_16x16x32_bf16 v[128:131], v[92:95], v[76:79], v[128:131]
  ds_read_b128 v[44:47], v23 offset:0
  v_mfma_f32_16x16x32_bf16 v[132:135], v[92:95], v[80:83], v[132:135]
  ds_read_b128 v[48:51], v23 offset:2048
  buffer_load_dwordx4 v12, s[8:11], s39 offen offset:0 lds
  v_mfma_f32_16x16x32_bf16 v[136:139], v[92:95], v[84:87], v[136:139]
  ds_read_b64_tr_b16 v[56:57], v27 offset:0
  v_mfma_f32_16x16x32_bf16 v[140:143], v[96:99], v[72:75], v[140:143]
  ds_read_b64_tr_b16 v[58:59], v27 offset:1536
  ds_read_b64_tr_b16 v[60:61], v28 offset:0
  v_mfma_f32_16x16x32_bf16 v[144:147], v[96:99], v[76:79], v[144:147]
  ds_read_b64_tr_b16 v[62:63], v28 offset:1536
  buffer_load_dwordx4 v13, s[8:11], s39 offen offset:1024 lds
  v_mfma_f32_16x16x32_bf16 v[148:151], v[96:99], v[80:83], v[148:151]
  ds_read_b64_tr_b16 v[64:65], v29 offset:0
  v_mfma_f32_16x16x32_bf16 v[152:155], v[96:99], v[84:87], v[152:155]
  ds_read_b64_tr_b16 v[66:67], v29 offset:1536
  v_mfma_f32_16x16x32_bf16 v[156:159], v[100:103], v[72:75], v[156:159]
  ds_read_b64_tr_b16 v[68:69], v30 offset:0
  buffer_load_dwordx4 v14, s[8:11], s39 offen offset:2048 lds
  v_mfma_f32_16x16x32_bf16 v[160:163], v[100:103], v[76:79], v[160:163]
  ds_read_b64_tr_b16 v[70:71], v30 offset:1536
  v_mfma_f32_16x16x32_bf16 v[164:167], v[100:103], v[80:83], v[164:167]
  v_mfma_f32_16x16x32_bf16 v[168:171], v[100:103], v[84:87], v[168:171]
  buffer_load_dwordx4 v15, s[8:11], s39 offen offset:3072 lds
  v_mfma_f32_16x16x32_bf16 v[172:175], v[104:107], v[72:75], v[172:175]
  v_mfma_f32_16x16x32_bf16 v[176:179], v[104:107], v[76:79], v[176:179]
  s_waitcnt lgkmcnt(11)
  v_mfma_f32_16x16x32_bf16 v[108:111], v[52:55], v[36:39], v[108:111]
  ds_read_b128 v[72:75], v24 offset:0
  ds_read_b64_tr_b16 v[88:89], v26 offset:12288
  s_waitcnt lgkmcnt(12)
  v_mfma_f32_16x16x32_bf16 v[112:115], v[52:55], v[40:43], v[112:115]
  ds_read_b64_tr_b16 v[90:91], v26 offset:13824
  s_add_u32 m0, s37, 49152
  s_add_u32 s39, s39, 128
  s_waitcnt lgkmcnt(12)
  v_mfma_f32_16x16x32_bf16 v[116:119], v[52:55], v[44:47], v[116:119]
  ds_read_b128 v[76:79], v24 offset:2048
  s_waitcnt lgkmcnt(12)
  v_mfma_f32_16x16x32_bf16 v[120:123], v[52:55], v[48:51], v[120:123]
  ds_read_b128 v[80:83], v25 offset:0
  buffer_load_dwordx4 v16, s[12:15], s40 offen offset:0 lds
  s_waitcnt lgkmcnt(11)
  v_mfma_f32_16x16x32_bf16 v[124:127], v[56:59], v[36:39], v[124:127]
  ds_read_b128 v[84:87], v25 offset:2048
  v_mfma_f32_16x16x32_bf16 v[128:131], v[56:59], v[40:43], v[128:131]
  ds_read_b64_tr_b16 v[92:93], v27 offset:12288
  buffer_load_dwordx4 v17, s[12:15], s40 offen offset:1024 lds
  v_mfma_f32_16x16x32_bf16 v[132:135], v[56:59], v[44:47], v[132:135]
  ds_read_b64_tr_b16 v[94:95], v27 offset:13824
  ds_read_b64_tr_b16 v[96:97], v28 offset:12288
  v_mfma_f32_16x16x32_bf16 v[136:139], v[56:59], v[48:51], v[136:139]
  ds_read_b64_tr_b16 v[98:99], v28 offset:13824
  buffer_load_dwordx4 v18, s[12:15], s40 offen offset:2048 lds
  s_waitcnt lgkmcnt(14)
  v_mfma_f32_16x16x32_bf16 v[140:143], v[60:63], v[36:39], v[140:143]
  ds_read_b64_tr_b16 v[100:101], v29 offset:12288
  v_mfma_f32_16x16x32_bf16 v[144:147], v[60:63], v[40:43], v[144:147]
  ds_read_b64_tr_b16 v[102:103], v29 offset:13824
  buffer_load_dwordx4 v19, s[12:15], s40 offen offset:3072 lds
  v_mfma_f32_16x16x32_bf16 v[148:151], v[60:63], v[44:47], v[148:151]
  ds_read_b64_tr_b16 v[104:105], v30 offset:12288
  v_mfma_f32_16x16x32_bf16 v[152:155], v[60:63], v[48:51], v[152:155]
  ds_read_b64_tr_b16 v[106:107], v30 offset:13824
  s_add_u32 m0, s37, 53248
  s_nop 0
  s_waitcnt lgkmcnt(15)
  v_mfma_f32_16x16x32_bf16 v[156:159], v[64:67], v[36:39], v[156:159]
  v_mfma_f32_16x16x32_bf16 v[160:163], v[64:67], v[40:43], v[160:163]
  buffer_load_dwordx4 v20, s[12:15], s40 offen offset:0 lds
  v_mfma_f32_16x16x32_bf16 v[164:167], v[64:67], v[44:47], v[164:167]
  v_mfma_f32_16x16x32_bf16 v[168:171], v[64:67], v[48:51], v[168:171]
  buffer_load_dwordx4 v21, s[12:15], s40 offen offset:1024 lds
  s_waitcnt lgkmcnt(14)
  v_mfma_f32_16x16x32_bf16 v[172:175], v[68:71], v[36:39], v[172:175]
  v_mfma_f32_16x16x32_bf16 v[176:179], v[68:71], v[40:43], v[176:179]
  s_add_u32 s35, s35, 1
  s_cmp_lt_u32 s35, 2
  s_cbranch_scc1 standalone__linear_attn_block__prompt_kernel_qq_loop
  s_waitcnt lgkmcnt(11)
  v_mfma_f32_16x16x32_bf16 v[108:111], v[88:91], v[72:75], v[108:111]
  s_waitcnt lgkmcnt(10)
  v_mfma_f32_16x16x32_bf16 v[112:115], v[88:91], v[76:79], v[112:115]
  s_waitcnt vmcnt(10) lgkmcnt(0)
  s_barrier
  v_mfma_f32_16x16x32_bf16 v[116:119], v[88:91], v[80:83], v[116:119]
  ds_read_b128 v[36:39], v22 offset:16384
  ds_read_b64_tr_b16 v[52:53], v26 offset:24576
  v_mfma_f32_16x16x32_bf16 v[120:123], v[88:91], v[84:87], v[120:123]
  ds_read_b64_tr_b16 v[54:55], v26 offset:26112
  s_mov_b32 m0, s65
  s_add_u32 s65, s65, 12288
  v_mfma_f32_16x16x32_bf16 v[124:127], v[92:95], v[72:75], v[124:127]
  ds_read_b128 v[40:43], v22 offset:18432
  buffer_load_dwordx4 v224, s[80:83], s66 offen lds
  v_mfma_f32_16x16x32_bf16 v[128:131], v[92:95], v[76:79], v[128:131]
  ds_read_b128 v[44:47], v23 offset:16384
  v_mfma_f32_16x16x32_bf16 v[132:135], v[92:95], v[80:83], v[132:135]
  ds_read_b128 v[48:51], v23 offset:18432
  buffer_load_dwordx4 v225, s[80:83], s66 offen offset:1024 lds
  v_mfma_f32_16x16x32_bf16 v[136:139], v[92:95], v[84:87], v[136:139]
  ds_read_b64_tr_b16 v[56:57], v27 offset:24576
  v_mfma_f32_16x16x32_bf16 v[140:143], v[96:99], v[72:75], v[140:143]
  ds_read_b64_tr_b16 v[58:59], v27 offset:26112
  ds_read_b64_tr_b16 v[60:61], v28 offset:24576
  buffer_load_dwordx4 v226, s[80:83], s66 offen offset:2048 lds
  s_add_u32 s66, s66, 73728
  v_mfma_f32_16x16x32_bf16 v[144:147], v[96:99], v[76:79], v[144:147]
  ds_read_b64_tr_b16 v[62:63], v28 offset:26112
  v_mfma_f32_16x16x32_bf16 v[148:151], v[96:99], v[80:83], v[148:151]
  ds_read_b64_tr_b16 v[64:65], v29 offset:24576
  s_mov_b32 m0, s65
  s_add_u32 s65, s65, 12288
  v_mfma_f32_16x16x32_bf16 v[152:155], v[96:99], v[84:87], v[152:155]
  ds_read_b64_tr_b16 v[66:67], v29 offset:26112
  v_mfma_f32_16x16x32_bf16 v[156:159], v[100:103], v[72:75], v[156:159]
  ds_read_b64_tr_b16 v[68:69], v30 offset:24576
  buffer_load_dwordx4 v224, s[80:83], s66 offen lds
  v_mfma_f32_16x16x32_bf16 v[160:163], v[100:103], v[76:79], v[160:163]
  ds_read_b64_tr_b16 v[70:71], v30 offset:26112
  v_mfma_f32_16x16x32_bf16 v[164:167], v[100:103], v[80:83], v[164:167]
  buffer_load_dwordx4 v225, s[80:83], s66 offen offset:1024 lds
  v_mfma_f32_16x16x32_bf16 v[168:171], v[100:103], v[84:87], v[168:171]
  v_mfma_f32_16x16x32_bf16 v[172:175], v[104:107], v[72:75], v[172:175]
  buffer_load_dwordx4 v226, s[80:83], s66 offen offset:2048 lds
  s_add_u32 s66, s66, 73728
  v_mfma_f32_16x16x32_bf16 v[176:179], v[104:107], v[76:79], v[176:179]
  s_waitcnt lgkmcnt(11)
  v_mfma_f32_16x16x32_bf16 v[108:111], v[52:55], v[36:39], v[108:111]
  ds_read_b128 v[72:75], v24 offset:16384
  ds_read_b64_tr_b16 v[88:89], v26 offset:36864
  s_waitcnt lgkmcnt(12)
  v_mfma_f32_16x16x32_bf16 v[112:115], v[52:55], v[40:43], v[112:115]
  ds_read_b64_tr_b16 v[90:91], v26 offset:38400
  s_mov_b32 m0, s65
  s_add_u32 s65, s65, 12288
  s_waitcnt lgkmcnt(12)
  v_mfma_f32_16x16x32_bf16 v[116:119], v[52:55], v[44:47], v[116:119]
  ds_read_b128 v[76:79], v24 offset:18432
  buffer_load_dwordx4 v224, s[80:83], s66 offen lds
  s_waitcnt lgkmcnt(12)
  v_mfma_f32_16x16x32_bf16 v[120:123], v[52:55], v[48:51], v[120:123]
  ds_read_b128 v[80:83], v25 offset:16384
  s_waitcnt lgkmcnt(11)
  v_mfma_f32_16x16x32_bf16 v[124:127], v[56:59], v[36:39], v[124:127]
  ds_read_b128 v[84:87], v25 offset:18432
  buffer_load_dwordx4 v225, s[80:83], s66 offen offset:1024 lds
  v_mfma_f32_16x16x32_bf16 v[128:131], v[56:59], v[40:43], v[128:131]
  ds_read_b64_tr_b16 v[92:93], v27 offset:36864
  buffer_load_dwordx4 v226, s[80:83], s66 offen offset:2048 lds
  s_add_u32 s66, s66, 73728
  v_mfma_f32_16x16x32_bf16 v[132:135], v[56:59], v[44:47], v[132:135]
  ds_read_b64_tr_b16 v[94:95], v27 offset:38400
  ds_read_b64_tr_b16 v[96:97], v28 offset:36864
  v_mfma_f32_16x16x32_bf16 v[136:139], v[56:59], v[48:51], v[136:139]
  ds_read_b64_tr_b16 v[98:99], v28 offset:38400
  s_cmp_ge_u32 s65, 163840
  s_cselect_b32 s18, 110592, 0
  s_cselect_b32 s19, 663552, 0
  s_sub_u32 s65, s65, s18
  s_sub_u32 s66, s66, s19
  s_waitcnt lgkmcnt(14)
  v_mfma_f32_16x16x32_bf16 v[140:143], v[60:63], v[36:39], v[140:143]
  ds_read_b64_tr_b16 v[100:101], v29 offset:36864
  v_mfma_f32_16x16x32_bf16 v[144:147], v[60:63], v[40:43], v[144:147]
  ds_read_b64_tr_b16 v[102:103], v29 offset:38400
  s_mov_b32 m0, s65
  s_add_u32 s65, s65, 12288
  v_mfma_f32_16x16x32_bf16 v[148:151], v[60:63], v[44:47], v[148:151]
  ds_read_b64_tr_b16 v[104:105], v30 offset:36864
  buffer_load_dwordx4 v224, s[80:83], s66 offen lds
  v_mfma_f32_16x16x32_bf16 v[152:155], v[60:63], v[48:51], v[152:155]
  ds_read_b64_tr_b16 v[106:107], v30 offset:38400
  s_waitcnt lgkmcnt(15)
  v_mfma_f32_16x16x32_bf16 v[156:159], v[64:67], v[36:39], v[156:159]
  buffer_load_dwordx4 v225, s[80:83], s66 offen offset:1024 lds
  v_mfma_f32_16x16x32_bf16 v[160:163], v[64:67], v[40:43], v[160:163]
  buffer_load_dwordx4 v226, s[80:83], s66 offen offset:2048 lds
  s_add_u32 s66, s66, 73728
  v_mfma_f32_16x16x32_bf16 v[164:167], v[64:67], v[44:47], v[164:167]
  v_mfma_f32_16x16x32_bf16 v[168:171], v[64:67], v[48:51], v[168:171]
  s_cmp_ge_u32 s65, 163840
  s_cselect_b32 s18, 110592, 0
  s_cselect_b32 s19, 663552, 0
  s_sub_u32 s65, s65, s18
  s_sub_u32 s66, s66, s19
  s_waitcnt lgkmcnt(14)
  v_mfma_f32_16x16x32_bf16 v[172:175], v[68:71], v[36:39], v[172:175]
  v_mfma_f32_16x16x32_bf16 v[176:179], v[68:71], v[40:43], v[176:179]
  s_waitcnt lgkmcnt(11)
  v_mfma_f32_16x16x32_bf16 v[108:111], v[88:91], v[72:75], v[108:111]
  s_waitcnt lgkmcnt(10)
  v_mfma_f32_16x16x32_bf16 v[112:115], v[88:91], v[76:79], v[112:115]
  s_waitcnt vmcnt(12) lgkmcnt(0)
  s_barrier
  v_mfma_f32_16x16x32_bf16 v[116:119], v[88:91], v[80:83], v[116:119]
  ds_read_b128 v[36:39], v22 offset:32768
  ds_read_b64_tr_b16 v[52:53], v26 offset:49152
  v_mfma_f32_16x16x32_bf16 v[120:123], v[88:91], v[84:87], v[120:123]
  ds_read_b64_tr_b16 v[54:55], v26 offset:50688
  s_mov_b32 m0, s65
  s_add_u32 s65, s65, 12288
  v_mfma_f32_16x16x32_bf16 v[124:127], v[92:95], v[72:75], v[124:127]
  ds_read_b128 v[40:43], v22 offset:34816
  v_mfma_f32_16x16x32_bf16 v[128:131], v[92:95], v[76:79], v[128:131]
  ds_read_b128 v[44:47], v23 offset:32768
  v_mfma_f32_16x16x32_bf16 v[132:135], v[92:95], v[80:83], v[132:135]
  ds_read_b128 v[48:51], v23 offset:34816
  buffer_load_dwordx4 v224, s[80:83], s66 offen lds
  v_mfma_f32_16x16x32_bf16 v[136:139], v[92:95], v[84:87], v[136:139]
  ds_read_b64_tr_b16 v[56:57], v27 offset:49152
  v_mfma_f32_16x16x32_bf16 v[140:143], v[96:99], v[72:75], v[140:143]
  ds_read_b64_tr_b16 v[58:59], v27 offset:50688
  ds_read_b64_tr_b16 v[60:61], v28 offset:49152
  v_mfma_f32_16x16x32_bf16 v[144:147], v[96:99], v[76:79], v[144:147]
  ds_read_b64_tr_b16 v[62:63], v28 offset:50688
  v_mfma_f32_16x16x32_bf16 v[148:151], v[96:99], v[80:83], v[148:151]
  ds_read_b64_tr_b16 v[64:65], v29 offset:49152
  buffer_load_dwordx4 v225, s[80:83], s66 offen offset:1024 lds
  v_mfma_f32_16x16x32_bf16 v[152:155], v[96:99], v[84:87], v[152:155]
  ds_read_b64_tr_b16 v[66:67], v29 offset:50688
  v_mfma_f32_16x16x32_bf16 v[156:159], v[100:103], v[72:75], v[156:159]
  ds_read_b64_tr_b16 v[68:69], v30 offset:49152
  v_mfma_f32_16x16x32_bf16 v[160:163], v[100:103], v[76:79], v[160:163]
  ds_read_b64_tr_b16 v[70:71], v30 offset:50688
  v_mfma_f32_16x16x32_bf16 v[164:167], v[100:103], v[80:83], v[164:167]
  buffer_load_dwordx4 v226, s[80:83], s66 offen offset:2048 lds
  s_add_u32 s66, s66, 73728
  v_mfma_f32_16x16x32_bf16 v[168:171], v[100:103], v[84:87], v[168:171]
  v_mfma_f32_16x16x32_bf16 v[172:175], v[104:107], v[72:75], v[172:175]
  v_mfma_f32_16x16x32_bf16 v[176:179], v[104:107], v[76:79], v[176:179]
  s_waitcnt lgkmcnt(11)
  v_mfma_f32_16x16x32_bf16 v[108:111], v[52:55], v[36:39], v[108:111]
  ds_read_b128 v[72:75], v24 offset:32768
  ds_read_b64_tr_b16 v[88:89], v26 offset:61440
  s_waitcnt lgkmcnt(12)
  v_mfma_f32_16x16x32_bf16 v[112:115], v[52:55], v[40:43], v[112:115]
  ds_read_b64_tr_b16 v[90:91], v26 offset:62976
  s_mov_b32 m0, s65
  s_add_u32 s65, s65, 12288
  s_waitcnt lgkmcnt(12)
  v_mfma_f32_16x16x32_bf16 v[116:119], v[52:55], v[44:47], v[116:119]
  ds_read_b128 v[76:79], v24 offset:34816
  s_waitcnt lgkmcnt(12)
  v_mfma_f32_16x16x32_bf16 v[120:123], v[52:55], v[48:51], v[120:123]
  ds_read_b128 v[80:83], v25 offset:32768
  s_waitcnt lgkmcnt(11)
  v_mfma_f32_16x16x32_bf16 v[124:127], v[56:59], v[36:39], v[124:127]
  ds_read_b128 v[84:87], v25 offset:34816
  v_mfma_f32_16x16x32_bf16 v[128:131], v[56:59], v[40:43], v[128:131]
  ds_read_b64_tr_b16 v[92:93], v27 offset:61440
  buffer_load_dwordx4 v224, s[80:83], s66 offen lds
  v_mfma_f32_16x16x32_bf16 v[132:135], v[56:59], v[44:47], v[132:135]
  ds_read_b64_tr_b16 v[94:95], v27 offset:62976
  ds_read_b64_tr_b16 v[96:97], v28 offset:61440
  v_mfma_f32_16x16x32_bf16 v[136:139], v[56:59], v[48:51], v[136:139]
  ds_read_b64_tr_b16 v[98:99], v28 offset:62976
  s_waitcnt lgkmcnt(14)
  v_mfma_f32_16x16x32_bf16 v[140:143], v[60:63], v[36:39], v[140:143]
  ds_read_b64_tr_b16 v[100:101], v29 offset:61440
  v_mfma_f32_16x16x32_bf16 v[144:147], v[60:63], v[40:43], v[144:147]
  ds_read_b64_tr_b16 v[102:103], v29 offset:62976
  buffer_load_dwordx4 v225, s[80:83], s66 offen offset:1024 lds
  v_mfma_f32_16x16x32_bf16 v[148:151], v[60:63], v[44:47], v[148:151]
  ds_read_b64_tr_b16 v[104:105], v30 offset:61440
  v_mfma_f32_16x16x32_bf16 v[152:155], v[60:63], v[48:51], v[152:155]
  ds_read_b64_tr_b16 v[106:107], v30 offset:62976
  s_waitcnt lgkmcnt(15)
  v_mfma_f32_16x16x32_bf16 v[156:159], v[64:67], v[36:39], v[156:159]
  v_mfma_f32_16x16x32_bf16 v[160:163], v[64:67], v[40:43], v[160:163]
  buffer_load_dwordx4 v226, s[80:83], s66 offen offset:2048 lds
  s_add_u32 s66, s66, 73728
  v_mfma_f32_16x16x32_bf16 v[164:167], v[64:67], v[44:47], v[164:167]
  v_mfma_f32_16x16x32_bf16 v[168:171], v[64:67], v[48:51], v[168:171]
  s_waitcnt lgkmcnt(14)
  v_mfma_f32_16x16x32_bf16 v[172:175], v[68:71], v[36:39], v[172:175]
  v_mfma_f32_16x16x32_bf16 v[176:179], v[68:71], v[40:43], v[176:179]
  s_waitcnt lgkmcnt(0)
  s_barrier
  v_mfma_f32_16x16x32_bf16 v[108:111], v[88:91], v[72:75], v[108:111]
  v_and_b32 v32, 7, v1
  v_lshlrev_b32 v32, 2, v32
  v_mfma_f32_16x16x32_bf16 v[112:115], v[88:91], v[76:79], v[112:115]
  global_load_dword v254, v32, s[76:77] sc1
  v_mfma_f32_16x16x32_bf16 v[116:119], v[88:91], v[80:83], v[116:119]
  s_lshl_b32 s29, s27, 3
  s_lshl_b32 s30, s45, 2
  s_add_u32 s29, s29, s30
  s_lshl_b32 s30, s44, 1
  v_mfma_f32_16x16x32_bf16 v[120:123], v[88:91], v[84:87], v[120:123]
  s_add_u32 s31, s29, s30
  s_mul_i32 s31, s31, 18432
  s_xor_b32 s30, s30, 2
  s_add_u32 s30, s29, s30
  s_mul_i32 s30, s30, 18432
  v_mfma_f32_16x16x32_bf16 v[124:127], v[92:95], v[72:75], v[124:127]
  s_lshl_b32 s29, s28, 2
  s_lshl_b32 s62, s44, 1
  s_add_u32 s29, s29, s62
  s_lshl_b32 s29, s29, 10
  v_mfma_f32_16x16x32_bf16 v[128:131], v[92:95], v[76:79], v[128:131]
  v_mfma_f32_16x16x32_bf16 v[132:135], v[92:95], v[80:83], v[132:135]
  v_lshlrev_b32 v6, 4, v1
  v_add_u32 v6, s29, v6
  v_add_u32 v22, s31, v6
  v_add_u32 v23, s30, v6
  v_mfma_f32_16x16x32_bf16 v[136:139], v[92:95], v[84:87], v[136:139]
  s_lshl_b32 s29, s28, 9
  s_add_u32 s29, s29, s31
  s_add_u32 s29, s29, 16384
  v_lshlrev_b32 v24, 3, v1
  v_add_u32 v24, s29, v24
  s_mov_b32 s63, 18432
  v_mfma_f32_16x16x32_bf16 v[140:143], v[96:99], v[72:75], v[140:143]
  s_mov_b32 m0, s65
  s_add_u32 s65, s65, 12288
  v_mfma_f32_16x16x32_bf16 v[144:147], v[96:99], v[76:79], v[144:147]
  buffer_load_dwordx4 v224, s[80:83], s66 offen lds
  v_mfma_f32_16x16x32_bf16 v[148:151], v[96:99], v[80:83], v[148:151]
  buffer_load_dwordx4 v225, s[80:83], s66 offen offset:1024 lds
  v_mfma_f32_16x16x32_bf16 v[152:155], v[96:99], v[84:87], v[152:155]
  v_mfma_f32_16x16x32_bf16 v[156:159], v[100:103], v[72:75], v[156:159]
  buffer_load_dwordx4 v226, s[80:83], s66 offen offset:2048 lds
  s_add_u32 s66, s66, 73728
  v_mfma_f32_16x16x32_bf16 v[160:163], v[100:103], v[76:79], v[160:163]
  s_mov_b32 m0, s65
  s_add_u32 s65, s65, 12288
  v_mfma_f32_16x16x32_bf16 v[164:167], v[100:103], v[80:83], v[164:167]
  buffer_load_dwordx4 v224, s[80:83], s66 offen lds
  v_mfma_f32_16x16x32_bf16 v[168:171], v[100:103], v[84:87], v[168:171]
  buffer_load_dwordx4 v225, s[80:83], s66 offen offset:1024 lds
  v_mfma_f32_16x16x32_bf16 v[172:175], v[104:107], v[72:75], v[172:175]
  buffer_load_dwordx4 v226, s[80:83], s66 offen offset:2048 lds
  s_add_u32 s66, s66, 73728
  v_mfma_f32_16x16x32_bf16 v[176:179], v[104:107], v[76:79], v[176:179]
  s_nop 5
  v_pk_fma_f32 v[2:3], v[108:109], s[50:51], v[34:35]
  v_pk_fma_f32 v[4:5], v[110:111], s[50:51], v[34:35]
  v_exp_f32_e64 v2, v2 clamp
  s_mov_b32 m0, s65
  s_add_u32 s65, s65, 12288
  v_exp_f32_e64 v3, v3 clamp
  v_exp_f32_e64 v4, v4 clamp
  v_exp_f32_e64 v5, v5 clamp
  v_pk_fma_f32 v[216:217], v[124:125], s[50:51], v[34:35]
  v_pk_fma_f32 v[218:219], v[126:127], s[50:51], v[34:35]
  v_exp_f32_e64 v216, v216 clamp
  v_max_f32 v108, v108, v2
  v_exp_f32_e64 v217, v217 clamp
  v_max_f32 v109, v109, v3
  buffer_load_dwordx4 v224, s[80:83], s66 offen lds
  v_exp_f32_e64 v218, v218 clamp
  v_max_f32 v110, v110, v4
  v_exp_f32_e64 v219, v219 clamp
  v_max_f32 v111, v111, v5
  v_pk_add_f32 v[108:109], v[108:109], s[52:53]
  v_pk_add_f32 v[110:111], v[110:111], s[52:53]
  v_cvt_pk_bf16_f32 v180, v108, v109
  v_cvt_pk_bf16_f32 v181, v110, v111
  v_pk_fma_f32 v[2:3], v[140:141], s[50:51], v[34:35]
  v_pk_fma_f32 v[4:5], v[142:143], s[50:51], v[34:35]
  buffer_load_dwordx4 v225, s[80:83], s66 offen offset:1024 lds
  v_exp_f32_e64 v2, v2 clamp
  v_max_f32 v124, v124, v216
  v_exp_f32_e64 v3, v3 clamp
  v_max_f32 v125, v125, v217
  v_exp_f32_e64 v4, v4 clamp
  v_max_f32 v126, v126, v218
  v_exp_f32_e64 v5, v5 clamp
  v_max_f32 v127, v127, v219
  v_pk_add_f32 v[124:125], v[124:125], s[52:53]
  buffer_load_dwordx4 v226, s[80:83], s66 offen offset:2048 lds
  s_add_u32 s66, s66, 73728
  v_pk_add_f32 v[126:127], v[126:127], s[52:53]
  v_cvt_pk_bf16_f32 v182, v124, v125
  v_cvt_pk_bf16_f32 v183, v126, v127
  buffer_store_dwordx4 v[180:183], v22, s[20:23], 0 offen offset:0 sc1
  v_pk_fma_f32 v[216:217], v[156:157], s[50:51], v[34:35]
  v_pk_fma_f32 v[218:219], v[158:159], s[50:51], v[34:35]
  v_exp_f32_e64 v216, v216 clamp
  v_max_f32 v140, v140, v2
  v_exp_f32_e64 v217, v217 clamp
  v_max_f32 v141, v141, v3
  v_exp_f32_e64 v218, v218 clamp
  v_max_f32 v142, v142, v4
  v_exp_f32_e64 v219, v219 clamp
  v_max_f32 v143, v143, v5
  v_pk_add_f32 v[140:141], v[140:141], s[52:53]
  v_pk_add_f32 v[142:143], v[142:143], s[52:53]
  v_cvt_pk_bf16_f32 v184, v140, v141
  v_cvt_pk_bf16_f32 v185, v142, v143
  v_pk_fma_f32 v[2:3], v[112:113], s[50:51], v[34:35]
  v_pk_fma_f32 v[4:5], v[114:115], s[50:51], v[34:35]
  v_exp_f32_e64 v2, v2 clamp
  v_max_f32 v156, v156, v216
  v_exp_f32_e64 v3, v3 clamp
  v_max_f32 v157, v157, v217
  v_exp_f32_e64 v4, v4 clamp
  v_max_f32 v158, v158, v218
  v_exp_f32_e64 v5, v5 clamp
  v_max_f32 v159, v159, v219
  v_pk_add_f32 v[156:157], v[156:157], s[52:53]
  v_pk_add_f32 v[158:159], v[158:159], s[52:53]
  v_cvt_pk_bf16_f32 v186, v156, v157
  v_cvt_pk_bf16_f32 v187, v158, v159
  buffer_store_dwordx4 v[184:187], v22, s[20:23], 0 offen offset:1024 sc1
  v_pk_fma_f32 v[216:217], v[128:129], s[50:51], v[34:35]
  v_pk_fma_f32 v[218:219], v[130:131], s[50:51], v[34:35]
  v_exp_f32_e64 v216, v216 clamp
  v_max_f32 v112, v112, v2
  v_exp_f32_e64 v217, v217 clamp
  v_max_f32 v113, v113, v3
  v_exp_f32_e64 v218, v218 clamp
  v_max_f32 v114, v114, v4
  v_exp_f32_e64 v219, v219 clamp
  v_max_f32 v115, v115, v5
  v_pk_add_f32 v[112:113], v[112:113], s[52:53]
  v_pk_add_f32 v[114:115], v[114:115], s[52:53]
  v_cvt_pk_bf16_f32 v188, v112, v113
  v_cvt_pk_bf16_f32 v189, v114, v115
  v_pk_fma_f32 v[2:3], v[144:145], s[50:51], v[34:35]
  v_pk_fma_f32 v[4:5], v[146:147], s[50:51], v[34:35]
  v_exp_f32_e64 v2, v2 clamp
  v_max_f32 v128, v128, v216
  v_exp_f32_e64 v3, v3 clamp
  v_max_f32 v129, v129, v217
  v_exp_f32_e64 v4, v4 clamp
  v_max_f32 v130, v130, v218
  v_exp_f32_e64 v5, v5 clamp
  v_max_f32 v131, v131, v219
  v_pk_add_f32 v[128:129], v[128:129], s[52:53]
  v_pk_add_f32 v[130:131], v[130:131], s[52:53]
  v_cvt_pk_bf16_f32 v190, v128, v129
  v_cvt_pk_bf16_f32 v191, v130, v131
  buffer_store_dwordx4 v[188:191], v22, s[20:23], s63 offen offset:0 sc1
  v_pk_fma_f32 v[216:217], v[160:161], s[50:51], v[34:35]
  v_pk_fma_f32 v[218:219], v[162:163], s[50:51], v[34:35]
  v_exp_f32_e64 v216, v216 clamp
  v_max_f32 v144, v144, v2
  v_exp_f32_e64 v217, v217 clamp
  v_max_f32 v145, v145, v3
  v_exp_f32_e64 v218, v218 clamp
  v_max_f32 v146, v146, v4
  v_exp_f32_e64 v219, v219 clamp
  v_max_f32 v147, v147, v5
  v_pk_add_f32 v[144:145], v[144:145], s[52:53]
  v_pk_add_f32 v[146:147], v[146:147], s[52:53]
  v_cvt_pk_bf16_f32 v192, v144, v145
  v_cvt_pk_bf16_f32 v193, v146, v147
  v_pk_fma_f32 v[2:3], v[116:117], s[50:51], v[34:35]
  v_pk_fma_f32 v[4:5], v[118:119], s[50:51], v[34:35]
  v_exp_f32_e64 v2, v2 clamp
  v_max_f32 v160, v160, v216
  v_exp_f32_e64 v3, v3 clamp
  v_max_f32 v161, v161, v217
  v_exp_f32_e64 v4, v4 clamp
  v_max_f32 v162, v162, v218
  v_exp_f32_e64 v5, v5 clamp
  v_max_f32 v163, v163, v219
  v_pk_add_f32 v[160:161], v[160:161], s[52:53]
  v_pk_add_f32 v[162:163], v[162:163], s[52:53]
  v_cvt_pk_bf16_f32 v194, v160, v161
  v_cvt_pk_bf16_f32 v195, v162, v163
  buffer_store_dwordx4 v[192:195], v22, s[20:23], s63 offen offset:1024 sc1
  v_pk_fma_f32 v[216:217], v[132:133], s[50:51], v[34:35]
  v_pk_fma_f32 v[218:219], v[134:135], s[50:51], v[34:35]
  v_exp_f32_e64 v216, v216 clamp
  v_max_f32 v116, v116, v2
  v_exp_f32_e64 v217, v217 clamp
  v_max_f32 v117, v117, v3
  v_exp_f32_e64 v218, v218 clamp
  v_max_f32 v118, v118, v4
  v_exp_f32_e64 v219, v219 clamp
  v_max_f32 v119, v119, v5
  v_pk_add_f32 v[116:117], v[116:117], s[52:53]
  v_pk_add_f32 v[118:119], v[118:119], s[52:53]
  v_cvt_pk_bf16_f32 v196, v116, v117
  v_cvt_pk_bf16_f32 v197, v118, v119
  v_pk_fma_f32 v[2:3], v[148:149], s[50:51], v[34:35]
  v_pk_fma_f32 v[4:5], v[150:151], s[50:51], v[34:35]
  v_exp_f32_e64 v2, v2 clamp
  v_max_f32 v132, v132, v216
  v_exp_f32_e64 v3, v3 clamp
  v_max_f32 v133, v133, v217
  v_exp_f32_e64 v4, v4 clamp
  v_max_f32 v134, v134, v218
  v_exp_f32_e64 v5, v5 clamp
  v_max_f32 v135, v135, v219
  v_pk_add_f32 v[132:133], v[132:133], s[52:53]
  v_pk_add_f32 v[134:135], v[134:135], s[52:53]
  v_cvt_pk_bf16_f32 v198, v132, v133
  v_cvt_pk_bf16_f32 v199, v134, v135
  buffer_store_dwordx4 v[196:199], v23, s[20:23], 0 offen offset:0 sc1
  v_pk_fma_f32 v[216:217], v[164:165], s[50:51], v[34:35]
  v_pk_fma_f32 v[218:219], v[166:167], s[50:51], v[34:35]
  v_exp_f32_e64 v216, v216 clamp
  v_max_f32 v148, v148, v2
  v_exp_f32_e64 v217, v217 clamp
  v_max_f32 v149, v149, v3
  v_exp_f32_e64 v218, v218 clamp
  v_max_f32 v150, v150, v4
  v_exp_f32_e64 v219, v219 clamp
  v_max_f32 v151, v151, v5
  v_pk_add_f32 v[148:149], v[148:149], s[52:53]
  v_pk_add_f32 v[150:151], v[150:151], s[52:53]
  v_cvt_pk_bf16_f32 v200, v148, v149
  v_cvt_pk_bf16_f32 v201, v150, v151
  v_pk_fma_f32 v[2:3], v[120:121], s[50:51], v[34:35]
  v_pk_fma_f32 v[4:5], v[122:123], s[50:51], v[34:35]
  v_exp_f32_e64 v2, v2 clamp
  v_max_f32 v164, v164, v216
  v_exp_f32_e64 v3, v3 clamp
  v_max_f32 v165, v165, v217
  v_exp_f32_e64 v4, v4 clamp
  v_max_f32 v166, v166, v218
  v_exp_f32_e64 v5, v5 clamp
  v_max_f32 v167, v167, v219
  v_pk_add_f32 v[164:165], v[164:165], s[52:53]
  v_pk_add_f32 v[166:167], v[166:167], s[52:53]
  v_cvt_pk_bf16_f32 v202, v164, v165
  v_cvt_pk_bf16_f32 v203, v166, v167
  buffer_store_dwordx4 v[200:203], v23, s[20:23], 0 offen offset:1024 sc1
  v_pk_fma_f32 v[216:217], v[136:137], s[50:51], v[34:35]
  v_pk_fma_f32 v[218:219], v[138:139], s[50:51], v[34:35]
  v_exp_f32_e64 v216, v216 clamp
  v_max_f32 v120, v120, v2
  v_exp_f32_e64 v217, v217 clamp
  v_max_f32 v121, v121, v3
  v_exp_f32_e64 v218, v218 clamp
  v_max_f32 v122, v122, v4
  v_exp_f32_e64 v219, v219 clamp
  v_max_f32 v123, v123, v5
  v_pk_add_f32 v[120:121], v[120:121], s[52:53]
  v_pk_add_f32 v[122:123], v[122:123], s[52:53]
  v_cvt_pk_bf16_f32 v204, v120, v121
  v_cvt_pk_bf16_f32 v205, v122, v123
  v_pk_fma_f32 v[2:3], v[152:153], s[50:51], v[34:35]
  v_pk_fma_f32 v[4:5], v[154:155], s[50:51], v[34:35]
  v_exp_f32_e64 v2, v2 clamp
  v_max_f32 v136, v136, v216
  v_exp_f32_e64 v3, v3 clamp
  v_max_f32 v137, v137, v217
  v_exp_f32_e64 v4, v4 clamp
  v_max_f32 v138, v138, v218
  v_exp_f32_e64 v5, v5 clamp
  v_max_f32 v139, v139, v219
  v_pk_add_f32 v[136:137], v[136:137], s[52:53]
  v_pk_add_f32 v[138:139], v[138:139], s[52:53]
  v_cvt_pk_bf16_f32 v206, v136, v137
  v_cvt_pk_bf16_f32 v207, v138, v139
  buffer_store_dwordx4 v[204:207], v23, s[20:23], s63 offen offset:0 sc1
  v_pk_fma_f32 v[216:217], v[168:169], s[50:51], v[34:35]
  v_pk_fma_f32 v[218:219], v[170:171], s[50:51], v[34:35]
  v_exp_f32_e64 v216, v216 clamp
  v_max_f32 v152, v152, v2
  v_exp_f32_e64 v217, v217 clamp
  v_max_f32 v153, v153, v3
  v_exp_f32_e64 v218, v218 clamp
  v_max_f32 v154, v154, v4
  v_exp_f32_e64 v219, v219 clamp
  v_max_f32 v155, v155, v5
  v_pk_add_f32 v[152:153], v[152:153], s[52:53]
  v_pk_add_f32 v[154:155], v[154:155], s[52:53]
  v_cvt_pk_bf16_f32 v208, v152, v153
  v_cvt_pk_bf16_f32 v209, v154, v155
  v_pk_fma_f32 v[2:3], v[172:173], s[50:51], v[34:35]
  v_pk_fma_f32 v[4:5], v[174:175], s[50:51], v[34:35]
  v_exp_f32_e64 v2, v2 clamp
  v_max_f32 v168, v168, v216
  v_exp_f32_e64 v3, v3 clamp
  v_max_f32 v169, v169, v217
  v_exp_f32_e64 v4, v4 clamp
  v_max_f32 v170, v170, v218
  v_exp_f32_e64 v5, v5 clamp
  v_max_f32 v171, v171, v219
  v_pk_add_f32 v[168:169], v[168:169], s[52:53]
  v_pk_add_f32 v[170:171], v[170:171], s[52:53]
  v_cvt_pk_bf16_f32 v210, v168, v169
  v_cvt_pk_bf16_f32 v211, v170, v171
  buffer_store_dwordx4 v[208:211], v23, s[20:23], s63 offen offset:1024 sc1
  v_pk_fma_f32 v[216:217], v[176:177], s[50:51], v[34:35]
  v_pk_fma_f32 v[218:219], v[178:179], s[50:51], v[34:35]
  v_exp_f32_e64 v216, v216 clamp
  v_max_f32 v172, v172, v2
  v_exp_f32_e64 v217, v217 clamp
  v_max_f32 v173, v173, v3
  v_exp_f32_e64 v218, v218 clamp
  v_max_f32 v174, v174, v4
  v_exp_f32_e64 v219, v219 clamp
  v_max_f32 v175, v175, v5
  v_pk_add_f32 v[172:173], v[172:173], s[52:53]
  v_pk_add_f32 v[174:175], v[174:175], s[52:53]
  v_cvt_pk_bf16_f32 v212, v172, v173
  v_cvt_pk_bf16_f32 v213, v174, v175
  buffer_store_dwordx2 v[212:213], v24, s[20:23], 0 offen sc1
  v_max_f32 v176, v176, v216
  v_max_f32 v177, v177, v217
  v_max_f32 v178, v178, v218
  v_max_f32 v179, v179, v219
  v_pk_add_f32 v[176:177], v[176:177], s[52:53]
  v_pk_add_f32 v[178:179], v[178:179], s[52:53]
  v_cvt_pk_bf16_f32 v214, v176, v177
  v_cvt_pk_bf16_f32 v215, v178, v179
  buffer_store_dwordx2 v[214:215], v24, s[20:23], s63 offen sc1
  s_lshl_b32 s3, s27, 7
  s_add_u32 s3, s3, 2418688
  s_mov_b32 s4, 1
standalone__linear_attn_block__prompt_kernel_signal:
  s_lshl_b32 s29, s64, 2
  s_lshl_b32 s30, s34, 1
  s_add_u32 s29, s29, s30
  s_mul_i32 s29, s29, 18432
  s_lshl_b32 s30, s33, 13
  s_add_u32 s30, s30, s29
  v_lshlrev_b32 v246, 4, v1
  v_add_u32 v246, s30, v246
  s_lshl_b32 s30, s33, 10
  s_add_u32 s30, s30, s29
  s_add_u32 s30, s30, 16384
  v_lshlrev_b32 v247, 3, v1
  v_add_u32 v247, s30, v247
  v_and_b32 v2, 127, v0
  s_mul_i32 s30, s33, 1600
  v_add_u32 v2, s30, v2
  v_lshlrev_b32 v248, 4, v2
  v_add_u32 v248, 2359296, v248
  v_lshlrev_b32 v249, 3, v2
  v_add_u32 v249, 0, v249
  s_mul_i32 s29, s33, 55296
  s_add_u32 s29, s29, 53248
  v_lshl_add_u32 v2, v9, 2, v10
  v_mul_u32_u24 v2, 192, v2
  v_lshl_add_u32 v2, v11, 3, v2
  v_add_u32 v2, s29, v2
  v_and_b32 v3, 1, v9
  v_lshl_add_u32 v227, v3, 5, v2
  v_xor_b32 v3, 1, v3
  v_lshl_add_u32 v228, v3, 5, v2
  v_mul_u32_u24 v2, 36, v10
  v_add3_u32 v2, v2, v9, 16
  v_mul_u32_u24 v2, 192, v2
  v_lshl_add_u32 v2, v11, 3, v2
  v_add_u32 v2, s29, v2
  v_and_b32 v3, 1, v10
  v_lshl_add_u32 v229, v3, 5, v2
  v_xor_b32 v3, 1, v3
  v_lshl_add_u32 v230, v3, 5, v2
  v_mov_b32 v152, 0
  v_mov_b32 v153, 0x358637bd
  v_mov_b32 v154, 0x358637bd
  v_mov_b32 v155, 0
  s_mov_b32 s35, 0
standalone__linear_attn_block__prompt_kernel_qpoll:
  s_waitcnt vmcnt(0)
  v_cmp_ne_u32 vcc, 1, v254
  s_nop 4
  s_cmp_eq_u64 vcc, 0
  s_cbranch_scc1 standalone__linear_attn_block__prompt_kernel_qgo
  s_add_u32 s35, s35, 1
  s_cmp_gt_u32 s35, 20000
  s_cbranch_scc1 standalone__linear_attn_block__prompt_kernel_qgo
  v_and_b32 v2, 7, v1
  v_lshlrev_b32 v2, 2, v2
  global_load_dword v254, v2, s[76:77] sc1
  s_branch standalone__linear_attn_block__prompt_kernel_qpoll
standalone__linear_attn_block__prompt_kernel_qgo:
  s_lshr_b32 s30, s64, 1
  s_lshl_b32 s30, s30, 7
  s_add_u32 s30, s30, 2418688
  v_mov_b32 v219, s30
  global_load_dword v218, v219, s[78:79] sc1
  s_barrier
  s_cmp_eq_u32 s24, 0
  s_cbranch_scc0 standalone__linear_attn_block__prompt_kernel_sig1
  v_lshlrev_b32 v2, 10, v1
  v_add_u32 v2, s3, v2
  v_mov_b32 v3, 1
  v_cmp_gt_u32 vcc, s4, v1
  s_and_saveexec_b64 s[54:55], vcc
  global_atomic_add v2, v3, s[78:79] sc1
  s_mov_b64 exec, s[54:55]
  s_waitcnt vmcnt(1)
  s_branch standalone__linear_attn_block__prompt_kernel_sig2
standalone__linear_attn_block__prompt_kernel_sig1:
  s_waitcnt vmcnt(0)
standalone__linear_attn_block__prompt_kernel_sig2:
  s_branch standalone__linear_attn_block__prompt_kernel_p2
standalone__linear_attn_block__prompt_kernel_helper:
  s_mov_b32 s10, 2359296
  s_mov_b32 s11, 0x20000
  s_mov_b32 s14, 1990656
  s_mov_b32 s15, 0x20000
  s_waitcnt lgkmcnt(0)
  s_mov_b32 s8, s68
  s_mov_b32 s9, s69
  s_mov_b32 s12, s70
  s_mov_b32 s13, s71
  s_mov_b32 s20, s78
  s_mov_b32 s21, s79
  s_mov_b32 s22, 2420736
  s_mov_b32 s23, 0x20000
  s_mov_b32 s80, s72
  s_mov_b32 s81, s73
  s_mov_b32 s82, 663552
  s_mov_b32 s83, 0x20000
  s_mov_b32 s84, s74
  s_mov_b32 s85, s75
  s_mov_b32 s86, 2359296
  s_mov_b32 s87, 0x20000
  s_cmp_ge_u32 s2, 8
  s_cbranch_scc1 standalone__linear_attn_block__prompt_kernel_hz
  s_cmp_eq_u32 s24, 3
  s_cbranch_scc0 standalone__linear_attn_block__prompt_kernel_hz
  s_mul_i32 s29, s2, 6400
  s_add_u32 s29, s29, 2359296
  v_lshlrev_b32 v2, 4, v1
  v_add_u32 v2, s29, v2
  v_mov_b32 v180, 0
  v_mov_b32 v181, 0
  v_mov_b32 v182, 0
  v_mov_b32 v183, 0
  global_store_dwordx4 v2, v[180:183], s[78:79] offset:0 sc1
  global_store_dwordx4 v2, v[180:183], s[78:79] offset:1024 sc1
  global_store_dwordx4 v2, v[180:183], s[78:79] offset:2048 sc1
  global_store_dwordx4 v2, v[180:183], s[78:79] offset:3072 sc1
  v_add_u32 v2, 4096, v2
  global_store_dwordx4 v2, v[180:183], s[78:79] offset:0 sc1
  global_store_dwordx4 v2, v[180:183], s[78:79] offset:1024 sc1
  v_cmp_gt_u32 vcc, 16, v1
  s_and_saveexec_b64 s[54:55], vcc
  global_store_dwordx4 v2, v[180:183], s[78:79] offset:2048 sc1
  s_mov_b64 exec, s[54:55]
  s_lshl_b32 s29, s2, 7
  s_add_u32 s29, s29, 2410496
  v_lshlrev_b32 v2, 10, v1
  v_add_u32 v2, s29, v2
  s_lshl_b32 s30, s2, 8
  s_add_u32 s30, s30, 2417664
  v_lshlrev_b32 v3, 7, v1
  v_add_u32 v3, s30, v3
  v_cmp_gt_u32 vcc, 8, v1
  s_nop 1
  v_cndmask_b32 v2, v3, v2, vcc
  v_cmp_gt_u32 vcc, 10, v1
  s_and_saveexec_b64 s[54:55], vcc
  global_store_dword v2, v180, s[78:79] sc1
  s_mov_b64 exec, s[54:55]
  s_waitcnt vmcnt(0)
  s_lshl_b32 s29, s2, 2
  v_mov_b32 v2, s29
  v_mov_b32 v3, 1
  v_cmp_eq_u32 vcc, 0, v1
  s_and_saveexec_b64 s[54:55], vcc
  global_store_dword v2, v3, s[76:77] sc1
  s_mov_b64 exec, s[54:55]
standalone__linear_attn_block__prompt_kernel_hz:
  s_and_b32 s29, s25, 3
  s_lshr_b32 s30, s25, 2
  s_cmp_eq_u32 s24, 3
  s_cbranch_scc1 standalone__linear_attn_block__prompt_kernel_hp_done
  s_cmp_eq_u32 s24, 0
  s_cbranch_scc0 standalone__linear_attn_block__prompt_kernel_hp_w
  s_lshl_b32 s29, s29, 9
  s_lshl_b32 s31, s26, 6
  s_add_u32 s29, s29, s31
  v_add_u32 v2, s29, v1
  v_mul_u32_u24 v2, 1152, v2
  buffer_load_dword v109, v2, s[8:11], 0 offen offset:128
  buffer_load_dword v110, v2, s[8:11], 0 offen offset:256
  buffer_load_dword v111, v2, s[8:11], 0 offen offset:384
  buffer_load_dword v112, v2, s[8:11], 0 offen offset:512
  buffer_load_dword v113, v2, s[8:11], 0 offen offset:640
  buffer_load_dword v114, v2, s[8:11], 0 offen offset:768
  buffer_load_dword v115, v2, s[8:11], 0 offen offset:896
  buffer_load_dword v116, v2, s[8:11], 0 offen offset:1024
  s_branch standalone__linear_attn_block__prompt_kernel_hp_done
standalone__linear_attn_block__prompt_kernel_hp_w:
  s_sub_u32 s31, s24, 1
  s_lshl_b32 s31, s31, 3
  v_and_b32 v3, 7, v1
  v_add_u32 v3, s31, v3
  s_lshl_b32 s31, s30, 2
  v_add_u32 v4, 9, v3
  v_add_u32 v5, 13, v3
  v_subrev_u32 v6, 10, v3
  v_cmp_gt_u32 vcc, 10, v3
  s_nop 1
  v_cndmask_b32 v6, v6, v5, vcc
  v_cmp_gt_u32 vcc, 5, v3
  s_nop 1
  v_cndmask_b32 v6, v6, v4, vcc
  v_add_u32 v6, s31, v6
  v_lshlrev_b32 v6, 7, v6
  s_lshl_b32 s31, s26, 3
  v_lshrrev_b32 v2, 3, v1
  v_add_u32 v2, s31, v2
  v_mul_u32_u24 v2, 3456, v2
  v_add_u32 v2, v2, v6
  v_cmp_ne_u32 vcc, 15, v3
  s_and_saveexec_b64 s[54:55], vcc
  s_mov_b32 s31, 221184
  buffer_load_dword v109, v2, s[12:15], s31 offen
  s_mov_b32 s31, 442368
  buffer_load_dword v110, v2, s[12:15], s31 offen
  s_mov_b32 s31, 663552
  buffer_load_dword v111, v2, s[12:15], s31 offen
  s_mov_b32 s31, 884736
  buffer_load_dword v112, v2, s[12:15], s31 offen
  s_mov_b32 s31, 1105920
  buffer_load_dword v113, v2, s[12:15], s31 offen
  s_mov_b32 s31, 1327104
  buffer_load_dword v114, v2, s[12:15], s31 offen
  s_mov_b32 s31, 1548288
  buffer_load_dword v115, v2, s[12:15], s31 offen
  s_mov_b32 s31, 1769472
  buffer_load_dword v116, v2, s[12:15], s31 offen
  s_mov_b64 exec, s[54:55]
standalone__linear_attn_block__prompt_kernel_hp_done:
  s_mul_i32 s29, s26, 648
  s_mul_i32 s30, s24, 162
  s_add_u32 s29, s29, s30
  s_lshl_b32 s29, s29, 7
  v_lshlrev_b32 v2, 7, v1
  v_add_u32 v2, s29, v2
  s_waitcnt vmcnt(2)
  buffer_load_dword v118, v2, s[80:83], 0 offen
  v_add_u32 v2, 8192, v2
  buffer_load_dword v119, v2, s[80:83], 0 offen
  v_add_u32 v2, 8192, v2
  v_cmp_gt_u32 vcc, 34, v1
  s_and_saveexec_b64 s[54:55], vcc
  buffer_load_dword v120, v2, s[80:83], 0 offen
  s_branch standalone__linear_attn_block__prompt_kernel_end
standalone__linear_attn_block__prompt_kernel_p2:
  s_mov_b32 s35, 0
standalone__linear_attn_block__prompt_kernel_pq_l:
  v_readfirstlane_b32 s29, v218
  s_nop 3
  s_cmp_eq_u32 s29, 4
  s_cbranch_scc1 standalone__linear_attn_block__prompt_kernel_pq_ok
  s_add_u32 s35, s35, 1
  s_cmp_gt_u32 s35, 20000
  s_cbranch_scc1 standalone__linear_attn_block__prompt_kernel_pq_ok
  s_sleep 4
  global_load_dword v218, v219, s[78:79] sc1
  s_waitcnt vmcnt(0)
  s_branch standalone__linear_attn_block__prompt_kernel_pq_l
standalone__linear_attn_block__prompt_kernel_pq_ok:
  s_mov_b32 s29, 0
  buffer_load_dwordx2 a[128:129], v247, s[20:23], s29 offen offset:0 sc1
  s_mov_b32 s29, 0
  buffer_load_dwordx2 a[130:131], v247, s[20:23], s29 offen offset:512 sc1
  s_mov_b32 s29, 18432
  buffer_load_dwordx2 a[132:133], v247, s[20:23], s29 offen offset:0 sc1
  s_mov_b32 s29, 18432
  buffer_load_dwordx2 a[134:135], v247, s[20:23], s29 offen offset:512 sc1
  s_mov_b32 s29, 0
  buffer_load_dwordx4 a[2:5], v246, s[20:23], s29 offen sc1
  s_mov_b32 s29, 18432
  buffer_load_dwordx4 a[66:69], v246, s[20:23], s29 offen sc1
  s_mov_b32 s29, 1024
  buffer_load_dwordx4 a[10:13], v246, s[20:23], s29 offen sc1
  s_mov_b32 s29, 19456
  buffer_load_dwordx4 a[74:77], v246, s[20:23], s29 offen sc1
  s_mov_b32 s29, 2048
  buffer_load_dwordx4 a[18:21], v246, s[20:23], s29 offen sc1
  s_mov_b32 s29, 20480
  buffer_load_dwordx4 a[82:85], v246, s[20:23], s29 offen sc1
  s_mov_b32 s29, 3072
  buffer_load_dwordx4 a[26:29], v246, s[20:23], s29 offen sc1
  s_mov_b32 s29, 21504
  buffer_load_dwordx4 a[90:93], v246, s[20:23], s29 offen sc1
  s_mov_b32 s29, 4096
  buffer_load_dwordx4 a[34:37], v246, s[20:23], s29 offen sc1
  s_mov_b32 s29, 22528
  buffer_load_dwordx4 a[98:101], v246, s[20:23], s29 offen sc1
  s_mov_b32 s29, 5120
  buffer_load_dwordx4 a[42:45], v246, s[20:23], s29 offen sc1
  s_mov_b32 s29, 23552
  buffer_load_dwordx4 a[106:109], v246, s[20:23], s29 offen sc1
  s_mov_b32 s29, 6144
  buffer_load_dwordx4 a[50:53], v246, s[20:23], s29 offen sc1
  s_mov_b32 s29, 24576
  buffer_load_dwordx4 a[114:117], v246, s[20:23], s29 offen sc1
  s_mov_b32 s29, 7168
  buffer_load_dwordx4 a[58:61], v246, s[20:23], s29 offen sc1
  s_mov_b32 s29, 25600
  buffer_load_dwordx4 a[122:125], v246, s[20:23], s29 offen sc1
  s_mul_i32 s29, s33, 12800
  s_add_u32 s29, s29, 0
  v_and_b32 v2, 3, v8
  v_lshrrev_b32 v3, 2, v8
  v_mov_b32 v4, 19
  v_mov_b32 v5, 19
  v_mov_b32 v6, 18
  v_cmp_eq_u32 vcc, 1, v2
  s_nop 1
  v_cndmask_b32 v4, v4, v6, vcc
  v_cmp_eq_u32 vcc, 2, v2
  s_nop 1
  v_cndmask_b32 v5, v5, v6, vcc
  v_add_u32 v6, 16, v3
  v_cmp_eq_u32 vcc, 0, v8
  s_nop 1
  v_cndmask_b32 v4, v4, v6, vcc
  v_cmp_eq_u32 vcc, 4, v8
  s_nop 1
  v_cndmask_b32 v4, v4, v6, vcc
  v_add_u32 v6, 14, v3
  v_cmp_eq_u32 vcc, 8, v8
  s_nop 1
  v_cndmask_b32 v5, v5, v6, vcc
  v_cmp_eq_u32 vcc, 12, v8
  s_nop 1
  v_cndmask_b32 v5, v5, v6, vcc
  v_mul_u32_u24 v6, 40, v8
  v_add_u32 v6, s29, v6
  v_mul_u32_u24 v4, 40, v4
  v_add_u32 v4, s29, v4
  v_mul_u32_u24 v5, 40, v5
  v_add_u32 v5, s29, v5
  v_lshl_add_u32 v231, v9, 3, v6
  v_lshl_add_u32 v232, v9, 3, v4
  v_lshl_add_u32 v233, v9, 3, v5
  s_add_u32 s30, s29, 760
  v_mov_b32 v2, s30
  v_cmp_eq_u32 vcc, 0, v9
  s_nop 1
  v_cndmask_b32 v234, v2, v6, vcc
  v_cndmask_b32 v238, v2, v4, vcc
  v_cndmask_b32 v242, v2, v5, vcc
  v_cmp_eq_u32 vcc, 1, v9
  s_nop 1
  v_cndmask_b32 v235, v2, v6, vcc
  v_cndmask_b32 v239, v2, v4, vcc
  v_cndmask_b32 v243, v2, v5, vcc
  v_cmp_eq_u32 vcc, 2, v9
  s_nop 1
  v_cndmask_b32 v236, v2, v6, vcc
  v_cndmask_b32 v240, v2, v4, vcc
  v_cndmask_b32 v244, v2, v5, vcc
  v_cmp_eq_u32 vcc, 3, v9
  s_nop 1
  v_cndmask_b32 v237, v2, v6, vcc
  v_cndmask_b32 v241, v2, v4, vcc
  v_cndmask_b32 v245, v2, v5, vcc
  v_cmp_gt_u32 s[60:61], 2, v9
  s_mul_i32 s29, s24, 6144
  s_add_u32 s29, s29, 25600
  v_lshlrev_b32 v2, 4, v1
  v_add_u32 v212, s29, v2
  s_xor_b32 s30, s24, 2
  s_mul_i32 s30, s30, 6144
  s_add_u32 s30, s30, 25600
  v_add_u32 v213, s30, v2
  s_mul_i32 s30, s24, 3328
  s_add_u32 s30, s30, 0
  v_mul_u32_u24 v253, 208, v8
  v_lshl_add_u32 v253, v9, 3, v253
  v_add_u32 v253, s30, v253
  v_mul_u32_u24 v6, 5462, v1
  v_lshrrev_b32 v6, 16, v6
  v_mul_u32_u24 v7, 12, v6
  v_sub_u32 v7, v1, v7
  v_mul_u32_u24 v6, 208, v6
  v_lshl_add_u32 v6, v7, 4, v6
  v_add_u32 v214, s30, v6
  v_add_u32 v5, 64, v1
  v_mul_u32_u24 v6, 5462, v5
  v_lshrrev_b32 v6, 16, v6
  v_mul_u32_u24 v7, 12, v6
  v_sub_u32 v7, v5, v7
  v_mul_u32_u24 v6, 208, v6
  v_lshl_add_u32 v6, v7, 4, v6
  v_add_u32 v215, s30, v6
  v_add_u32 v5, 128, v1
  v_mul_u32_u24 v6, 5462, v5
  v_lshrrev_b32 v6, 16, v6
  v_mul_u32_u24 v7, 12, v6
  v_sub_u32 v7, v5, v7
  v_mul_u32_u24 v6, 208, v6
  v_lshl_add_u32 v6, v7, 4, v6
  v_add_u32 v216, s30, v6
  s_waitcnt vmcnt(16)
  v_accvgpr_mov_b32 a0, a128
  v_accvgpr_mov_b32 a6, a128
  v_accvgpr_mov_b32 a1, a129
  v_accvgpr_mov_b32 a7, a129
  v_accvgpr_mov_b32 a8, a128
  v_accvgpr_mov_b32 a14, a128
  v_accvgpr_mov_b32 a9, a129
  v_accvgpr_mov_b32 a15, a129
  v_accvgpr_mov_b32 a16, a128
  v_accvgpr_mov_b32 a22, a128
  v_accvgpr_mov_b32 a17, a129
  v_accvgpr_mov_b32 a23, a129
  v_accvgpr_mov_b32 a24, a128
  v_accvgpr_mov_b32 a30, a128
  v_accvgpr_mov_b32 a25, a129
  v_accvgpr_mov_b32 a31, a129
  v_accvgpr_mov_b32 a32, a130
  v_accvgpr_mov_b32 a38, a130
  v_accvgpr_mov_b32 a33, a131
  v_accvgpr_mov_b32 a39, a131
  v_accvgpr_mov_b32 a40, a130
  v_accvgpr_mov_b32 a46, a130
  v_accvgpr_mov_b32 a41, a131
  v_accvgpr_mov_b32 a47, a131
  v_accvgpr_mov_b32 a48, a130
  v_accvgpr_mov_b32 a54, a130
  v_accvgpr_mov_b32 a49, a131
  v_accvgpr_mov_b32 a55, a131
  v_accvgpr_mov_b32 a56, a130
  v_accvgpr_mov_b32 a62, a130
  v_accvgpr_mov_b32 a57, a131
  v_accvgpr_mov_b32 a63, a131
  v_accvgpr_mov_b32 a64, a132
  v_accvgpr_mov_b32 a70, a132
  v_accvgpr_mov_b32 a65, a133
  v_accvgpr_mov_b32 a71, a133
  v_accvgpr_mov_b32 a72, a132
  v_accvgpr_mov_b32 a78, a132
  v_accvgpr_mov_b32 a73, a133
  v_accvgpr_mov_b32 a79, a133
  v_accvgpr_mov_b32 a80, a132
  v_accvgpr_mov_b32 a86, a132
  v_accvgpr_mov_b32 a81, a133
  v_accvgpr_mov_b32 a87, a133
  v_accvgpr_mov_b32 a88, a132
  v_accvgpr_mov_b32 a94, a132
  v_accvgpr_mov_b32 a89, a133
  v_accvgpr_mov_b32 a95, a133
  v_accvgpr_mov_b32 a96, a134
  v_accvgpr_mov_b32 a102, a134
  v_accvgpr_mov_b32 a97, a135
  v_accvgpr_mov_b32 a103, a135
  v_accvgpr_mov_b32 a104, a134
  v_accvgpr_mov_b32 a110, a134
  v_accvgpr_mov_b32 a105, a135
  v_accvgpr_mov_b32 a111, a135
  v_accvgpr_mov_b32 a112, a134
  v_accvgpr_mov_b32 a118, a134
  v_accvgpr_mov_b32 a113, a135
  v_accvgpr_mov_b32 a119, a135
  v_accvgpr_mov_b32 a120, a134
  v_accvgpr_mov_b32 a126, a134
  v_accvgpr_mov_b32 a121, a135
  v_accvgpr_mov_b32 a127, a135
  s_cmp_eq_u32 s24, 0
  s_cbranch_scc0 standalone__linear_attn_block__prompt_kernel_pk_d
  s_and_b32 s29, s2, 7
  s_lshl_b32 s29, s29, 10
  s_add_u32 s29, s29, 2410496
  v_lshlrev_b32 v2, 7, v1
  v_add_u32 v2, s29, v2
  v_cmp_gt_u32 vcc, 8, v1
  s_and_saveexec_b64 s[54:55], vcc
  s_mov_b32 s35, 0
  global_load_dword v220, v2, s[78:79] sc1
standalone__linear_attn_block__prompt_kernel_pk_l:
  global_load_dword v221, v2, s[78:79] sc1
  s_waitcnt vmcnt(1)
  v_cmp_ne_u32 vcc, 16, v220
  s_nop 4
  s_cmp_eq_u64 vcc, 0
  s_cbranch_scc1 standalone__linear_attn_block__prompt_kernel_pk_ok
  global_load_dword v220, v2, s[78:79] sc1
  s_waitcnt vmcnt(1)
  v_cmp_ne_u32 vcc, 16, v221
  s_nop 4
  s_cmp_eq_u64 vcc, 0
  s_cbranch_scc1 standalone__linear_attn_block__prompt_kernel_pk_ok
  s_add_u32 s35, s35, 1
  s_cmp_gt_u32 s35, 20000
  s_cbranch_scc0 standalone__linear_attn_block__prompt_kernel_pk_l
standalone__linear_attn_block__prompt_kernel_pk_ok:
  s_mov_b64 exec, s[54:55]
standalone__linear_attn_block__prompt_kernel_pk_d:
  s_barrier
  s_mov_b32 s29, 0
  buffer_load_dwordx4 v[156:159], v248, s[20:23], s29 offen sc1
  s_mov_b32 s29, 2048
  buffer_load_dwordx4 v[160:163], v248, s[20:23], s29 offen sc1
  s_mov_b32 s29, 4096
  buffer_load_dwordx4 v[164:167], v248, s[20:23], s29 offen sc1
  s_mov_b32 s29, 6144
  buffer_load_dwordx4 v[168:171], v248, s[20:23], s29 offen sc1
  s_mov_b32 s29, 8192
  buffer_load_dwordx4 v[172:175], v248, s[20:23], s29 offen sc1
  s_mov_b32 s29, 10240
  buffer_load_dwordx4 v[176:179], v248, s[20:23], s29 offen sc1
  s_mov_b32 s29, 12288
  buffer_load_dwordx4 v[180:183], v248, s[20:23], s29 offen sc1
  s_mov_b32 s29, 14336
  buffer_load_dwordx4 v[184:187], v248, s[20:23], s29 offen sc1
  s_mov_b32 s29, 16384
  buffer_load_dwordx4 v[188:191], v248, s[20:23], s29 offen sc1
  s_mov_b32 s29, 18432
  buffer_load_dwordx4 v[192:195], v248, s[20:23], s29 offen sc1
  s_mov_b32 s29, 20480
  buffer_load_dwordx4 v[196:199], v248, s[20:23], s29 offen sc1
  s_mov_b32 s29, 22528
  buffer_load_dwordx4 v[200:203], v248, s[20:23], s29 offen sc1
  s_cmp_eq_u32 s34, 0
  s_cbranch_scc0 standalone__linear_attn_block__prompt_kernel_k12
  s_mov_b32 s29, 24576
  buffer_load_dwordx4 v[108:111], v248, s[20:23], s29 offen sc1
  s_branch standalone__linear_attn_block__prompt_kernel_k12b
standalone__linear_attn_block__prompt_kernel_k12:
  s_mov_b32 s29, 0
  buffer_load_dword v108, v248, s[20:23], s29 offen sc1
standalone__linear_attn_block__prompt_kernel_k12b:
  s_waitcnt vmcnt(12)
  v_cvt_pk_bf16_f32 v156, v156, v157
  v_cvt_pk_bf16_f32 v157, v158, v159
  ds_write_b64 v249, v[156:157] offset:0
  s_waitcnt vmcnt(11)
  v_cvt_pk_bf16_f32 v160, v160, v161
  v_cvt_pk_bf16_f32 v161, v162, v163
  ds_write_b64 v249, v[160:161] offset:1024
  s_waitcnt vmcnt(10)
  v_cvt_pk_bf16_f32 v164, v164, v165
  v_cvt_pk_bf16_f32 v165, v166, v167
  ds_write_b64 v249, v[164:165] offset:2048
  s_waitcnt vmcnt(9)
  v_cvt_pk_bf16_f32 v168, v168, v169
  v_cvt_pk_bf16_f32 v169, v170, v171
  ds_write_b64 v249, v[168:169] offset:3072
  s_waitcnt lgkmcnt(0)
  s_barrier
  ds_read_b64 a[144:145], v238 offset:32
  ds_read_b64 a[146:147], v232 offset:0
  ds_read_b64 a[136:137], v234 offset:32
  ds_read_b64 a[138:139], v231 offset:0
  ds_read_b64 a[140:141], v231 offset:808
  ds_read_b64 a[142:143], v234 offset:800
  ds_read_b64 a[148:149], v233 offset:808
  ds_read_b64 a[150:151], v242 offset:800
  ds_read_b64 a[160:161], v239 offset:1632
  ds_read_b64 a[162:163], v232 offset:1600
  ds_read_b64 a[152:153], v235 offset:1632
  ds_read_b64 a[154:155], v231 offset:1600
  ds_read_b64 a[156:157], v231 offset:2408
  ds_read_b64 a[158:159], v235 offset:2400
  ds_read_b64 a[164:165], v233 offset:2408
  ds_read_b64 a[166:167], v243 offset:2400
  s_waitcnt lgkmcnt(8)
  v_mfma_f32_16x16x32_bf16 v[68:71], a[144:147], a[0:3], v[152:155]
  v_mfma_f32_16x16x32_bf16 v[60:63], a[136:139], a[0:3], 0
  v_mfma_f32_16x16x32_bf16 v[64:67], a[140:143], a[4:7], 0
  v_mfma_f32_16x16x32_bf16 v[68:71], a[148:151], a[4:7], v[68:71]
  v_mfma_f32_16x16x32_bf16 v[80:83], a[144:147], a[64:67], v[152:155]
  v_mfma_f32_16x16x32_bf16 v[72:75], a[136:139], a[64:67], 0
  v_mfma_f32_16x16x32_bf16 v[76:79], a[140:143], a[68:71], 0
  v_mfma_f32_16x16x32_bf16 v[80:83], a[148:151], a[68:71], v[80:83]
  ds_read_b64_tr_b16 a[168:169], v227 offset:0
  ds_read_b64_tr_b16 a[170:171], v228 offset:3840
  ds_read_b64_tr_b16 a[172:173], v228 offset:0
  ds_read_b64_tr_b16 a[174:175], v227 offset:3840
  ds_read_b64_tr_b16 a[176:177], v227 offset:64
  ds_read_b64_tr_b16 a[178:179], v228 offset:3904
  ds_read_b64_tr_b16 a[180:181], v228 offset:64
  ds_read_b64_tr_b16 a[182:183], v227 offset:3904
  ds_read_b64_tr_b16 a[184:185], v227 offset:128
  ds_read_b64_tr_b16 a[186:187], v228 offset:3968
  ds_read_b64_tr_b16 a[188:189], v228 offset:128
  ds_read_b64_tr_b16 a[190:191], v227 offset:3968
  v_rcp_f32 v144, v69
  v_rcp_f32 v146, v70
  s_nop 0
  v_mul_f32 v60, v60, v144
  v_mul_f32 v61, v61, v144
  v_mul_f32 v62, v62, v144
  v_mul_f32 v63, v63, v144
  v_mul_f32 v64, v64, v146
  v_mul_f32 v65, v65, v146
  v_mul_f32 v66, v66, v146
  v_mul_f32 v67, v67, v146
  v_cndmask_b32 v145, v146, v144, s[60:61]
  v_cvt_pk_bf16_f32 v112, v60, v61
  v_cvt_pk_bf16_f32 v113, v62, v63
  v_cvt_pk_bf16_f32 v114, v64, v65
  v_cvt_pk_bf16_f32 v115, v66, v67
  v_mul_f32 v128, v68, v145
  v_rcp_f32 v148, v81
  v_rcp_f32 v150, v82
  s_nop 0
  v_mul_f32 v72, v72, v148
  v_mul_f32 v73, v73, v148
  v_mul_f32 v74, v74, v148
  v_mul_f32 v75, v75, v148
  v_mul_f32 v76, v76, v150
  v_mul_f32 v77, v77, v150
  v_mul_f32 v78, v78, v150
  v_mul_f32 v79, v79, v150
  v_cndmask_b32 v149, v150, v148, s[60:61]
  v_cvt_pk_bf16_f32 v116, v72, v73
  v_cvt_pk_bf16_f32 v117, v74, v75
  v_cvt_pk_bf16_f32 v118, v76, v77
  v_cvt_pk_bf16_f32 v119, v78, v79
  v_mul_f32 v136, v80, v149
  s_waitcnt lgkmcnt(12)
  v_mfma_f32_16x16x32_bf16 v[92:95], a[160:163], a[8:11], v[152:155]
  ds_read_b64_tr_b16 a[192:193], v228 offset:6912
  ds_read_b64_tr_b16 a[194:195], v227 offset:10752
  s_waitcnt vmcnt(8)
  v_cvt_pk_bf16_f32 v172, v172, v173
  v_cvt_pk_bf16_f32 v173, v174, v175
  ds_write_b64 v249, v[172:173] offset:4096
  v_mfma_f32_16x16x32_bf16 v[84:87], a[152:155], a[8:11], 0
  ds_read_b64_tr_b16 a[196:197], v227 offset:6912
  s_waitcnt vmcnt(7)
  v_cvt_pk_bf16_f32 v176, v176, v177
  v_cvt_pk_bf16_f32 v177, v178, v179
  ds_write_b64 v249, v[176:177] offset:5120
  v_mfma_f32_16x16x32_bf16 v[88:91], a[156:159], a[12:15], 0
  ds_read_b64_tr_b16 a[198:199], v228 offset:10752
  s_waitcnt vmcnt(6)
  v_cvt_pk_bf16_f32 v180, v180, v181
  v_cvt_pk_bf16_f32 v181, v182, v183
  ds_write_b64 v249, v[180:181] offset:6144
  v_mfma_f32_16x16x32_bf16 v[92:95], a[164:167], a[12:15], v[92:95]
  ds_read_b64_tr_b16 a[200:201], v228 offset:6976
  s_waitcnt vmcnt(5)
  v_cvt_pk_bf16_f32 v184, v184, v185
  v_cvt_pk_bf16_f32 v185, v186, v187
  ds_write_b64 v249, v[184:185] offset:7168
  v_mfma_f32_16x16x32_bf16 v[104:107], a[160:163], a[72:75], v[152:155]
  ds_read_b64_tr_b16 a[202:203], v227 offset:10816
  s_waitcnt vmcnt(4)
  v_cvt_pk_bf16_f32 v188, v188, v189
  v_cvt_pk_bf16_f32 v189, v190, v191
  ds_write_b64 v249, v[188:189] offset:8192
  v_mfma_f32_16x16x32_bf16 v[96:99], a[152:155], a[72:75], 0
  ds_read_b64_tr_b16 a[204:205], v227 offset:6976
  ds_read_b64_tr_b16 a[206:207], v228 offset:10816
  v_mfma_f32_16x16x32_bf16 v[100:103], a[156:159], a[76:79], 0
  ds_read_b64_tr_b16 a[208:209], v228 offset:7040
  s_waitcnt vmcnt(3)
  v_cvt_pk_bf16_f32 v192, v192, v193
  v_cvt_pk_bf16_f32 v193, v194, v195
  ds_write_b64 v249, v[192:193] offset:9216
  v_mfma_f32_16x16x32_bf16 v[104:107], a[164:167], a[76:79], v[104:107]
  ds_read_b64_tr_b16 a[210:211], v227 offset:10880
  s_waitcnt vmcnt(2)
  v_cvt_pk_bf16_f32 v196, v196, v197
  v_cvt_pk_bf16_f32 v197, v198, v199
  ds_write_b64 v249, v[196:197] offset:10240
  v_rcp_f32 v144, v93
  v_rcp_f32 v146, v94
  v_mul_f32 v84, v84, v144
  s_waitcnt lgkmcnt(15)
  v_mfma_f32_16x16x32_bf16 v[12:15], a[168:171], v[112:115], 0
  ds_read_b64_tr_b16 a[212:213], v227 offset:7040
  s_waitcnt vmcnt(1)
  v_cvt_pk_bf16_f32 v200, v200, v201
  v_cvt_pk_bf16_f32 v201, v202, v203
  ds_write_b64 v249, v[200:201] offset:11264
  v_mul_f32 v85, v85, v144
  v_mul_f32 v86, v86, v144
  v_mul_f32 v87, v87, v144
  v_mfma_f32_16x16x32_bf16 v[36:39], a[168:171], v[116:119], 0
  ds_read_b64_tr_b16 a[214:215], v228 offset:10880
  s_waitcnt vmcnt(0)
  s_cmp_eq_u32 s34, 0
  s_cbranch_scc0 Lk12_1
  v_cvt_pk_bf16_f32 v108, v108, v109
  v_cvt_pk_bf16_f32 v109, v110, v111
  ds_write_b64 v249, v[108:109] offset:12288
Lk12_1:
  v_mul_f32 v88, v88, v146
  v_mul_f32 v89, v89, v146
  v_mfma_f32_16x16x32_bf16 v[16:19], a[172:175], v[112:115], 0
  v_mul_f32 v90, v90, v146
  v_mul_f32 v91, v91, v146
  v_cndmask_b32 v145, v146, v144, s[60:61]
  v_mfma_f32_16x16x32_bf16 v[40:43], a[172:175], v[116:119], 0
  s_waitcnt lgkmcnt(0)
  s_barrier
  v_cvt_pk_bf16_f32 v120, v84, v85
  v_cvt_pk_bf16_f32 v121, v86, v87
  v_cvt_pk_bf16_f32 v122, v88, v89
  v_mfma_f32_16x16x32_bf16 v[20:23], a[176:179], v[112:115], 0
  ds_read_b64 a[144:145], v240 offset:3232
  v_cvt_pk_bf16_f32 v123, v90, v91
  v_mul_f32 v129, v92, v145
  v_mfma_f32_16x16x32_bf16 v[44:47], a[176:179], v[116:119], 0
  ds_read_b64 a[146:147], v232 offset:3200
  v_rcp_f32 v148, v105
  v_rcp_f32 v150, v106
  v_mul_f32 v96, v96, v148
  v_mfma_f32_16x16x32_bf16 v[24:27], a[180:183], v[112:115], 0
  ds_read_b64 a[136:137], v236 offset:3232
  v_mul_f32 v97, v97, v148
  v_mul_f32 v98, v98, v148
  v_mfma_f32_16x16x32_bf16 v[48:51], a[180:183], v[116:119], 0
  ds_read_b64 a[138:139], v231 offset:3200
  v_mul_f32 v99, v99, v148
  v_mul_f32 v100, v100, v150
  v_mfma_f32_16x16x32_bf16 v[28:31], a[184:187], v[112:115], 0
  ds_read_b64 a[140:141], v231 offset:4008
  v_mul_f32 v101, v101, v150
  v_mul_f32 v102, v102, v150
  v_mul_f32 v103, v103, v150
  v_mfma_f32_16x16x32_bf16 v[52:55], a[184:187], v[116:119], 0
  ds_read_b64 a[142:143], v236 offset:4000
  v_cndmask_b32 v149, v150, v148, s[60:61]
  v_cvt_pk_bf16_f32 v124, v96, v97
  v_mfma_f32_16x16x32_bf16 v[32:35], a[188:191], v[112:115], 0
  ds_read_b64 a[148:149], v233 offset:4008
  v_cvt_pk_bf16_f32 v125, v98, v99
  v_cvt_pk_bf16_f32 v126, v100, v101
  v_mfma_f32_16x16x32_bf16 v[56:59], a[188:191], v[116:119], 0
  ds_read_b64 a[150:151], v244 offset:4000
  v_cvt_pk_bf16_f32 v127, v102, v103
  v_mul_f32 v137, v104, v149
  s_nop 1
  s_waitcnt lgkmcnt(0)
  v_mfma_f32_16x16x32_bf16 v[68:71], a[144:147], a[16:19], v[152:155]
  ds_read_b64 a[160:161], v241 offset:4832
  ds_read_b64 a[162:163], v232 offset:4800
  v_mfma_f32_16x16x32_bf16 v[60:63], a[136:139], a[16:19], 0
  ds_read_b64 a[152:153], v237 offset:4832
  v_mfma_f32_16x16x32_bf16 v[64:67], a[140:143], a[20:23], 0
  ds_read_b64 a[154:155], v231 offset:4800
  v_mfma_f32_16x16x32_bf16 v[68:71], a[148:151], a[20:23], v[68:71]
  ds_read_b64 a[156:157], v231 offset:5608
  v_mfma_f32_16x16x32_bf16 v[80:83], a[144:147], a[80:83], v[152:155]
  ds_read_b64 a[158:159], v237 offset:5600
  v_mfma_f32_16x16x32_bf16 v[72:75], a[136:139], a[80:83], 0
  ds_read_b64 a[164:165], v233 offset:5608
  v_mfma_f32_16x16x32_bf16 v[76:79], a[140:143], a[84:87], 0
  ds_read_b64 a[166:167], v245 offset:5600
  v_mfma_f32_16x16x32_bf16 v[80:83], a[148:151], a[84:87], v[80:83]
  ds_read_b64_tr_b16 a[168:169], v227 offset:13824
  v_rcp_f32 v144, v69
  v_rcp_f32 v146, v70
  v_mul_f32 v60, v60, v144
  v_mfma_f32_16x16x32_bf16 v[12:15], a[192:195], v[120:123], v[12:15]
  ds_read_b64_tr_b16 a[170:171], v228 offset:17664
  v_mul_f32 v61, v61, v144
  v_mul_f32 v62, v62, v144
  v_mul_f32 v63, v63, v144
  v_mfma_f32_16x16x32_bf16 v[36:39], a[192:195], v[124:127], v[36:39]
  ds_read_b64_tr_b16 a[172:173], v228 offset:13824
  ds_read_b64_tr_b16 a[174:175], v227 offset:17664
  v_mul_f32 v64, v64, v146
  v_mul_f32 v65, v65, v146
  v_mfma_f32_16x16x32_bf16 v[16:19], a[196:199], v[120:123], v[16:19]
  ds_read_b64_tr_b16 a[176:177], v227 offset:13888
  v_mul_f32 v66, v66, v146
  v_mul_f32 v67, v67, v146
  v_cndmask_b32 v145, v146, v144, s[60:61]
  v_mfma_f32_16x16x32_bf16 v[40:43], a[196:199], v[124:127], v[40:43]
  ds_read_b64_tr_b16 a[178:179], v228 offset:17728
  v_cvt_pk_bf16_f32 v112, v60, v61
  v_cvt_pk_bf16_f32 v113, v62, v63
  v_cvt_pk_bf16_f32 v114, v64, v65
  v_mfma_f32_16x16x32_bf16 v[20:23], a[200:203], v[120:123], v[20:23]
  ds_read_b64_tr_b16 a[180:181], v228 offset:13888
  v_cvt_pk_bf16_f32 v115, v66, v67
  v_mul_f32 v130, v68, v145
  v_mfma_f32_16x16x32_bf16 v[44:47], a[200:203], v[124:127], v[44:47]
  ds_read_b64_tr_b16 a[182:183], v227 offset:17728
  v_rcp_f32 v148, v81
  v_rcp_f32 v150, v82
  v_mul_f32 v72, v72, v148
  v_mfma_f32_16x16x32_bf16 v[24:27], a[204:207], v[120:123], v[24:27]
  ds_read_b64_tr_b16 a[184:185], v227 offset:13952
  v_mul_f32 v73, v73, v148
  v_mul_f32 v74, v74, v148
  v_mfma_f32_16x16x32_bf16 v[48:51], a[204:207], v[124:127], v[48:51]
  ds_read_b64_tr_b16 a[186:187], v228 offset:17792
  v_mul_f32 v75, v75, v148
  v_mul_f32 v76, v76, v150
  v_mfma_f32_16x16x32_bf16 v[28:31], a[208:211], v[120:123], v[28:31]
  ds_read_b64_tr_b16 a[188:189], v228 offset:13952
  v_mul_f32 v77, v77, v150
  v_mul_f32 v78, v78, v150
  v_mul_f32 v79, v79, v150
  v_mfma_f32_16x16x32_bf16 v[52:55], a[208:211], v[124:127], v[52:55]
  ds_read_b64_tr_b16 a[190:191], v227 offset:17792
  v_cndmask_b32 v149, v150, v148, s[60:61]
  v_cvt_pk_bf16_f32 v116, v72, v73
  v_mfma_f32_16x16x32_bf16 v[32:35], a[212:215], v[120:123], v[32:35]
  v_cvt_pk_bf16_f32 v117, v74, v75
  v_cvt_pk_bf16_f32 v118, v76, v77
  v_mfma_f32_16x16x32_bf16 v[56:59], a[212:215], v[124:127], v[56:59]
  v_cvt_pk_bf16_f32 v119, v78, v79
  v_mul_f32 v138, v80, v149
  s_nop 1
  s_waitcnt lgkmcnt(12)
  v_mfma_f32_16x16x32_bf16 v[92:95], a[160:163], a[24:27], v[152:155]
  ds_read_b64 a[144:145], v238 offset:6432
  ds_read_b64 a[146:147], v232 offset:6400
  v_mfma_f32_16x16x32_bf16 v[84:87], a[152:155], a[24:27], 0
  ds_read_b64 a[136:137], v234 offset:6432
  v_mfma_f32_16x16x32_bf16 v[88:91], a[156:159], a[28:31], 0
  ds_read_b64 a[138:139], v231 offset:6400
  v_mfma_f32_16x16x32_bf16 v[92:95], a[164:167], a[28:31], v[92:95]
  ds_read_b64 a[140:141], v231 offset:7208
  v_mfma_f32_16x16x32_bf16 v[104:107], a[160:163], a[88:91], v[152:155]
  ds_read_b64 a[142:143], v234 offset:7200
  v_mfma_f32_16x16x32_bf16 v[96:99], a[152:155], a[88:91], 0
  ds_read_b64 a[148:149], v233 offset:7208
  v_mfma_f32_16x16x32_bf16 v[100:103], a[156:159], a[92:95], 0
  ds_read_b64 a[150:151], v242 offset:7200
  v_mfma_f32_16x16x32_bf16 v[104:107], a[164:167], a[92:95], v[104:107]
  ds_read_b64_tr_b16 a[192:193], v228 offset:20736
  v_rcp_f32 v144, v93
  v_rcp_f32 v146, v94
  v_mul_f32 v84, v84, v144
  s_waitcnt lgkmcnt(9)
  v_mfma_f32_16x16x32_bf16 v[12:15], a[168:171], v[112:115], v[12:15]
  ds_read_b64_tr_b16 a[194:195], v227 offset:24576
  v_mul_f32 v85, v85, v144
  v_mul_f32 v86, v86, v144
  v_mul_f32 v87, v87, v144
  v_mfma_f32_16x16x32_bf16 v[36:39], a[168:171], v[116:119], v[36:39]
  ds_read_b64_tr_b16 a[196:197], v227 offset:20736
  ds_read_b64_tr_b16 a[198:199], v228 offset:24576
  v_mul_f32 v88, v88, v146
  v_mul_f32 v89, v89, v146
  v_mfma_f32_16x16x32_bf16 v[16:19], a[172:175], v[112:115], v[16:19]
  ds_read_b64_tr_b16 a[200:201], v228 offset:20800
  v_mul_f32 v90, v90, v146
  v_mul_f32 v91, v91, v146
  v_cndmask_b32 v145, v146, v144, s[60:61]
  v_mfma_f32_16x16x32_bf16 v[40:43], a[172:175], v[116:119], v[40:43]
  ds_read_b64_tr_b16 a[202:203], v227 offset:24640
  v_cvt_pk_bf16_f32 v120, v84, v85
  v_cvt_pk_bf16_f32 v121, v86, v87
  v_cvt_pk_bf16_f32 v122, v88, v89
  v_mfma_f32_16x16x32_bf16 v[20:23], a[176:179], v[112:115], v[20:23]
  ds_read_b64_tr_b16 a[204:205], v227 offset:20800
  v_cvt_pk_bf16_f32 v123, v90, v91
  v_mul_f32 v131, v92, v145
  v_mfma_f32_16x16x32_bf16 v[44:47], a[176:179], v[116:119], v[44:47]
  ds_read_b64_tr_b16 a[206:207], v228 offset:24640
  v_rcp_f32 v148, v105
  v_rcp_f32 v150, v106
  v_mul_f32 v96, v96, v148
  v_mfma_f32_16x16x32_bf16 v[24:27], a[180:183], v[112:115], v[24:27]
  ds_read_b64_tr_b16 a[208:209], v228 offset:20864
  v_mul_f32 v97, v97, v148
  v_mul_f32 v98, v98, v148
  v_mfma_f32_16x16x32_bf16 v[48:51], a[180:183], v[116:119], v[48:51]
  ds_read_b64_tr_b16 a[210:211], v227 offset:24704
  v_mul_f32 v99, v99, v148
  v_mul_f32 v100, v100, v150
  v_mfma_f32_16x16x32_bf16 v[28:31], a[184:187], v[112:115], v[28:31]
  ds_read_b64_tr_b16 a[212:213], v227 offset:20864
  v_mul_f32 v101, v101, v150
  v_mul_f32 v102, v102, v150
  v_mul_f32 v103, v103, v150
  v_mfma_f32_16x16x32_bf16 v[52:55], a[184:187], v[116:119], v[52:55]
  ds_read_b64_tr_b16 a[214:215], v228 offset:24704
  v_cndmask_b32 v149, v150, v148, s[60:61]
  v_cvt_pk_bf16_f32 v124, v96, v97
  v_mfma_f32_16x16x32_bf16 v[32:35], a[188:191], v[112:115], v[32:35]
  v_cvt_pk_bf16_f32 v125, v98, v99
  v_cvt_pk_bf16_f32 v126, v100, v101
  v_mfma_f32_16x16x32_bf16 v[56:59], a[188:191], v[116:119], v[56:59]
  v_cvt_pk_bf16_f32 v127, v102, v103
  v_mul_f32 v139, v104, v149
  s_nop 1
  s_waitcnt lgkmcnt(12)
  v_mfma_f32_16x16x32_bf16 v[68:71], a[144:147], a[32:35], v[152:155]
  ds_read_b64 a[160:161], v239 offset:8032
  ds_read_b64 a[162:163], v232 offset:8000
  v_mfma_f32_16x16x32_bf16 v[60:63], a[136:139], a[32:35], 0
  ds_read_b64 a[152:153], v235 offset:8032
  v_mfma_f32_16x16x32_bf16 v[64:67], a[140:143], a[36:39], 0
  ds_read_b64 a[154:155], v231 offset:8000
  v_mfma_f32_16x16x32_bf16 v[68:71], a[148:151], a[36:39], v[68:71]
  ds_read_b64 a[156:157], v231 offset:8808
  v_mfma_f32_16x16x32_bf16 v[80:83], a[144:147], a[96:99], v[152:155]
  ds_read_b64 a[158:159], v235 offset:8800
  v_mfma_f32_16x16x32_bf16 v[72:75], a[136:139], a[96:99], 0
  ds_read_b64 a[164:165], v233 offset:8808
  v_mfma_f32_16x16x32_bf16 v[76:79], a[140:143], a[100:103], 0
  ds_read_b64 a[166:167], v243 offset:8800
  v_mfma_f32_16x16x32_bf16 v[80:83], a[148:151], a[100:103], v[80:83]
  ds_read_b64_tr_b16 a[168:169], v227 offset:27648
  v_rcp_f32 v144, v69
  v_rcp_f32 v146, v70
  v_mul_f32 v60, v60, v144
  s_waitcnt lgkmcnt(9)
  v_mfma_f32_16x16x32_bf16 v[12:15], a[192:195], v[120:123], v[12:15]
  ds_read_b64_tr_b16 a[170:171], v228 offset:31488
  v_mul_f32 v61, v61, v144
  v_mul_f32 v62, v62, v144
  v_mul_f32 v63, v63, v144
  v_mfma_f32_16x16x32_bf16 v[36:39], a[192:195], v[124:127], v[36:39]
  ds_read_b64_tr_b16 a[172:173], v228 offset:27648
  ds_read_b64_tr_b16 a[174:175], v227 offset:31488
  v_mul_f32 v64, v64, v146
  v_mul_f32 v65, v65, v146
  v_mfma_f32_16x16x32_bf16 v[16:19], a[196:199], v[120:123], v[16:19]
  ds_read_b64_tr_b16 a[176:177], v227 offset:27712
  v_mul_f32 v66, v66, v146
  v_mul_f32 v67, v67, v146
  v_cndmask_b32 v145, v146, v144, s[60:61]
  v_mfma_f32_16x16x32_bf16 v[40:43], a[196:199], v[124:127], v[40:43]
  ds_read_b64_tr_b16 a[178:179], v228 offset:31552
  v_cvt_pk_bf16_f32 v112, v60, v61
  v_cvt_pk_bf16_f32 v113, v62, v63
  v_cvt_pk_bf16_f32 v114, v64, v65
  v_mfma_f32_16x16x32_bf16 v[20:23], a[200:203], v[120:123], v[20:23]
  ds_read_b64_tr_b16 a[180:181], v228 offset:27712
  v_cvt_pk_bf16_f32 v115, v66, v67
  v_mul_f32 v132, v68, v145
  v_mfma_f32_16x16x32_bf16 v[44:47], a[200:203], v[124:127], v[44:47]
  ds_read_b64_tr_b16 a[182:183], v227 offset:31552
  v_rcp_f32 v148, v81
  v_rcp_f32 v150, v82
  v_mul_f32 v72, v72, v148
  v_mfma_f32_16x16x32_bf16 v[24:27], a[204:207], v[120:123], v[24:27]
  ds_read_b64_tr_b16 a[184:185], v227 offset:27776
  v_mul_f32 v73, v73, v148
  v_mul_f32 v74, v74, v148
  v_mfma_f32_16x16x32_bf16 v[48:51], a[204:207], v[124:127], v[48:51]
  ds_read_b64_tr_b16 a[186:187], v228 offset:31616
  v_mul_f32 v75, v75, v148
  v_mul_f32 v76, v76, v150
  v_mfma_f32_16x16x32_bf16 v[28:31], a[208:211], v[120:123], v[28:31]
  ds_read_b64_tr_b16 a[188:189], v228 offset:27776
  v_mul_f32 v77, v77, v150
  v_mul_f32 v78, v78, v150
  v_mul_f32 v79, v79, v150
  v_mfma_f32_16x16x32_bf16 v[52:55], a[208:211], v[124:127], v[52:55]
  ds_read_b64_tr_b16 a[190:191], v227 offset:31616
  v_cndmask_b32 v149, v150, v148, s[60:61]
  v_cvt_pk_bf16_f32 v116, v72, v73
  v_mfma_f32_16x16x32_bf16 v[32:35], a[212:215], v[120:123], v[32:35]
  v_cvt_pk_bf16_f32 v117, v74, v75
  v_cvt_pk_bf16_f32 v118, v76, v77
  v_mfma_f32_16x16x32_bf16 v[56:59], a[212:215], v[124:127], v[56:59]
  v_cvt_pk_bf16_f32 v119, v78, v79
  v_mul_f32 v140, v80, v149
  s_nop 1
  s_waitcnt lgkmcnt(12)
  v_mfma_f32_16x16x32_bf16 v[92:95], a[160:163], a[40:43], v[152:155]
  ds_read_b64 a[144:145], v240 offset:9632
  ds_read_b64 a[146:147], v232 offset:9600
  v_mfma_f32_16x16x32_bf16 v[84:87], a[152:155], a[40:43], 0
  ds_read_b64 a[136:137], v236 offset:9632
  v_mfma_f32_16x16x32_bf16 v[88:91], a[156:159], a[44:47], 0
  ds_read_b64 a[138:139], v231 offset:9600
  v_mfma_f32_16x16x32_bf16 v[92:95], a[164:167], a[44:47], v[92:95]
  ds_read_b64 a[140:141], v231 offset:10408
  v_mfma_f32_16x16x32_bf16 v[104:107], a[160:163], a[104:107], v[152:155]
  ds_read_b64 a[142:143], v236 offset:10400
  v_mfma_f32_16x16x32_bf16 v[96:99], a[152:155], a[104:107], 0
  ds_read_b64 a[148:149], v233 offset:10408
  v_mfma_f32_16x16x32_bf16 v[100:103], a[156:159], a[108:111], 0
  ds_read_b64 a[150:151], v244 offset:10400
  v_mfma_f32_16x16x32_bf16 v[104:107], a[164:167], a[108:111], v[104:107]
  ds_read_b64_tr_b16 a[192:193], v228 offset:34560
  v_rcp_f32 v144, v93
  v_rcp_f32 v146, v94
  v_mul_f32 v84, v84, v144
  s_waitcnt lgkmcnt(9)
  v_mfma_f32_16x16x32_bf16 v[12:15], a[168:171], v[112:115], v[12:15]
  ds_read_b64_tr_b16 a[194:195], v227 offset:38400
  v_mul_f32 v85, v85, v144
  v_mul_f32 v86, v86, v144
  v_mul_f32 v87, v87, v144
  v_mfma_f32_16x16x32_bf16 v[36:39], a[168:171], v[116:119], v[36:39]
  ds_read_b64_tr_b16 a[196:197], v227 offset:34560
  ds_read_b64_tr_b16 a[198:199], v228 offset:38400
  v_mul_f32 v88, v88, v146
  v_mul_f32 v89, v89, v146
  v_mfma_f32_16x16x32_bf16 v[16:19], a[172:175], v[112:115], v[16:19]
  ds_read_b64_tr_b16 a[200:201], v228 offset:34624
  v_mul_f32 v90, v90, v146
  v_mul_f32 v91, v91, v146
  v_cndmask_b32 v145, v146, v144, s[60:61]
  v_mfma_f32_16x16x32_bf16 v[40:43], a[172:175], v[116:119], v[40:43]
  ds_read_b64_tr_b16 a[202:203], v227 offset:38464
  v_cvt_pk_bf16_f32 v120, v84, v85
  v_cvt_pk_bf16_f32 v121, v86, v87
  v_cvt_pk_bf16_f32 v122, v88, v89
  v_mfma_f32_16x16x32_bf16 v[20:23], a[176:179], v[112:115], v[20:23]
  ds_read_b64_tr_b16 a[204:205], v227 offset:34624
  v_cvt_pk_bf16_f32 v123, v90, v91
  v_mul_f32 v133, v92, v145
  v_mfma_f32_16x16x32_bf16 v[44:47], a[176:179], v[116:119], v[44:47]
  ds_read_b64_tr_b16 a[206:207], v228 offset:38464
  v_rcp_f32 v148, v105
  v_rcp_f32 v150, v106
  v_mul_f32 v96, v96, v148
  v_mfma_f32_16x16x32_bf16 v[24:27], a[180:183], v[112:115], v[24:27]
  ds_read_b64_tr_b16 a[208:209], v228 offset:34688
  v_mul_f32 v97, v97, v148
  v_mul_f32 v98, v98, v148
  v_mfma_f32_16x16x32_bf16 v[48:51], a[180:183], v[116:119], v[48:51]
  ds_read_b64_tr_b16 a[210:211], v227 offset:38528
  v_mul_f32 v99, v99, v148
  v_mul_f32 v100, v100, v150
  v_mfma_f32_16x16x32_bf16 v[28:31], a[184:187], v[112:115], v[28:31]
  ds_read_b64_tr_b16 a[212:213], v227 offset:34688
  v_mul_f32 v101, v101, v150
  v_mul_f32 v102, v102, v150
  v_mul_f32 v103, v103, v150
  v_mfma_f32_16x16x32_bf16 v[52:55], a[184:187], v[116:119], v[52:55]
  ds_read_b64_tr_b16 a[214:215], v228 offset:38528
  v_cndmask_b32 v149, v150, v148, s[60:61]
  v_cvt_pk_bf16_f32 v124, v96, v97
  v_mfma_f32_16x16x32_bf16 v[32:35], a[188:191], v[112:115], v[32:35]
  v_cvt_pk_bf16_f32 v125, v98, v99
  v_cvt_pk_bf16_f32 v126, v100, v101
  v_mfma_f32_16x16x32_bf16 v[56:59], a[188:191], v[116:119], v[56:59]
  v_cvt_pk_bf16_f32 v127, v102, v103
  v_mul_f32 v141, v104, v149
  s_nop 1
  s_waitcnt lgkmcnt(12)
  v_mfma_f32_16x16x32_bf16 v[68:71], a[144:147], a[48:51], v[152:155]
  ds_read_b64 a[160:161], v241 offset:11232
  ds_read_b64 a[162:163], v232 offset:11200
  v_mfma_f32_16x16x32_bf16 v[60:63], a[136:139], a[48:51], 0
  ds_read_b64 a[152:153], v237 offset:11232
  v_mfma_f32_16x16x32_bf16 v[64:67], a[140:143], a[52:55], 0
  ds_read_b64 a[154:155], v231 offset:11200
  v_mfma_f32_16x16x32_bf16 v[68:71], a[148:151], a[52:55], v[68:71]
  ds_read_b64 a[156:157], v231 offset:12008
  v_mfma_f32_16x16x32_bf16 v[80:83], a[144:147], a[112:115], v[152:155]
  ds_read_b64 a[158:159], v237 offset:12000
  v_mfma_f32_16x16x32_bf16 v[72:75], a[136:139], a[112:115], 0
  ds_read_b64 a[164:165], v233 offset:12008
  v_mfma_f32_16x16x32_bf16 v[76:79], a[140:143], a[116:119], 0
  ds_read_b64 a[166:167], v245 offset:12000
  v_mfma_f32_16x16x32_bf16 v[80:83], a[148:151], a[116:119], v[80:83]
  ds_read_b64_tr_b16 a[168:169], v227 offset:41472
  v_rcp_f32 v144, v69
  v_rcp_f32 v146, v70
  v_mul_f32 v60, v60, v144
  s_waitcnt lgkmcnt(9)
  v_mfma_f32_16x16x32_bf16 v[12:15], a[192:195], v[120:123], v[12:15]
  ds_read_b64_tr_b16 a[170:171], v228 offset:45312
  v_mul_f32 v61, v61, v144
  v_mul_f32 v62, v62, v144
  v_mul_f32 v63, v63, v144
  v_mfma_f32_16x16x32_bf16 v[36:39], a[192:195], v[124:127], v[36:39]
  ds_read_b64_tr_b16 a[172:173], v228 offset:41472
  ds_read_b64_tr_b16 a[174:175], v227 offset:45312
  v_mul_f32 v64, v64, v146
  v_mul_f32 v65, v65, v146
  v_mfma_f32_16x16x32_bf16 v[16:19], a[196:199], v[120:123], v[16:19]
  ds_read_b64_tr_b16 a[176:177], v227 offset:41536
  v_mul_f32 v66, v66, v146
  v_mul_f32 v67, v67, v146
  v_cndmask_b32 v145, v146, v144, s[60:61]
  v_mfma_f32_16x16x32_bf16 v[40:43], a[196:199], v[124:127], v[40:43]
  ds_read_b64_tr_b16 a[178:179], v228 offset:45376
  v_cvt_pk_bf16_f32 v112, v60, v61
  v_cvt_pk_bf16_f32 v113, v62, v63
  v_cvt_pk_bf16_f32 v114, v64, v65
  v_mfma_f32_16x16x32_bf16 v[20:23], a[200:203], v[120:123], v[20:23]
  ds_read_b64_tr_b16 a[180:181], v228 offset:41536
  v_cvt_pk_bf16_f32 v115, v66, v67
  v_mul_f32 v134, v68, v145
  v_mfma_f32_16x16x32_bf16 v[44:47], a[200:203], v[124:127], v[44:47]
  ds_read_b64_tr_b16 a[182:183], v227 offset:45376
  v_rcp_f32 v148, v81
  v_rcp_f32 v150, v82
  v_mul_f32 v72, v72, v148
  v_mfma_f32_16x16x32_bf16 v[24:27], a[204:207], v[120:123], v[24:27]
  ds_read_b64_tr_b16 a[184:185], v227 offset:41600
  v_mul_f32 v73, v73, v148
  v_mul_f32 v74, v74, v148
  v_mfma_f32_16x16x32_bf16 v[48:51], a[204:207], v[124:127], v[48:51]
  ds_read_b64_tr_b16 a[186:187], v228 offset:45440
  v_mul_f32 v75, v75, v148
  v_mul_f32 v76, v76, v150
  v_mfma_f32_16x16x32_bf16 v[28:31], a[208:211], v[120:123], v[28:31]
  ds_read_b64_tr_b16 a[188:189], v228 offset:41600
  v_mul_f32 v77, v77, v150
  v_mul_f32 v78, v78, v150
  v_mul_f32 v79, v79, v150
  v_mfma_f32_16x16x32_bf16 v[52:55], a[208:211], v[124:127], v[52:55]
  ds_read_b64_tr_b16 a[190:191], v227 offset:45440
  v_cndmask_b32 v149, v150, v148, s[60:61]
  v_cvt_pk_bf16_f32 v116, v72, v73
  v_mfma_f32_16x16x32_bf16 v[32:35], a[212:215], v[120:123], v[32:35]
  v_cvt_pk_bf16_f32 v117, v74, v75
  v_cvt_pk_bf16_f32 v118, v76, v77
  v_mfma_f32_16x16x32_bf16 v[56:59], a[212:215], v[124:127], v[56:59]
  v_cvt_pk_bf16_f32 v119, v78, v79
  v_mul_f32 v142, v80, v149
  s_nop 1
  s_waitcnt lgkmcnt(12)
  v_mfma_f32_16x16x32_bf16 v[92:95], a[160:163], a[56:59], v[152:155]
  ds_read_b64_tr_b16 a[192:193], v228 offset:48384
  v_mfma_f32_16x16x32_bf16 v[84:87], a[152:155], a[56:59], 0
  ds_read_b64_tr_b16 a[194:195], v227 offset:52224
  v_mfma_f32_16x16x32_bf16 v[88:91], a[156:159], a[60:63], 0
  v_mfma_f32_16x16x32_bf16 v[92:95], a[164:167], a[60:63], v[92:95]
  ds_read_b64_tr_b16 a[196:197], v227 offset:48384
  v_mfma_f32_16x16x32_bf16 v[104:107], a[160:163], a[120:123], v[152:155]
  ds_read_b64_tr_b16 a[198:199], v228 offset:52224
  v_mfma_f32_16x16x32_bf16 v[96:99], a[152:155], a[120:123], 0
  v_mfma_f32_16x16x32_bf16 v[100:103], a[156:159], a[124:127], 0
  ds_read_b64_tr_b16 a[200:201], v228 offset:48448
  v_mfma_f32_16x16x32_bf16 v[104:107], a[164:167], a[124:127], v[104:107]
  ds_read_b64_tr_b16 a[202:203], v227 offset:52288
  s_nop 0
  v_rcp_f32 v144, v93
  v_rcp_f32 v146, v94
  v_mul_f32 v84, v84, v144
  s_waitcnt lgkmcnt(6)
  v_mfma_f32_16x16x32_bf16 v[12:15], a[168:171], v[112:115], v[12:15]
  v_mul_f32 v85, v85, v144
  v_mul_f32 v86, v86, v144
  v_mul_f32 v87, v87, v144
  v_mfma_f32_16x16x32_bf16 v[36:39], a[168:171], v[116:119], v[36:39]
  ds_read_b64_tr_b16 a[204:205], v227 offset:48448
  v_mul_f32 v88, v88, v146
  v_mul_f32 v89, v89, v146
  v_mfma_f32_16x16x32_bf16 v[16:19], a[172:175], v[112:115], v[16:19]
  ds_read_b64_tr_b16 a[206:207], v228 offset:52288
  v_mul_f32 v90, v90, v146
  v_mul_f32 v91, v91, v146
  v_cndmask_b32 v145, v146, v144, s[60:61]
  v_mfma_f32_16x16x32_bf16 v[40:43], a[172:175], v[116:119], v[40:43]
  v_cvt_pk_bf16_f32 v120, v84, v85
  v_cvt_pk_bf16_f32 v121, v86, v87
  v_cvt_pk_bf16_f32 v122, v88, v89
  v_mfma_f32_16x16x32_bf16 v[20:23], a[176:179], v[112:115], v[20:23]
  ds_read_b64_tr_b16 a[208:209], v228 offset:48512
  v_cvt_pk_bf16_f32 v123, v90, v91
  v_mul_f32 v135, v92, v145
  v_mfma_f32_16x16x32_bf16 v[44:47], a[176:179], v[116:119], v[44:47]
  ds_read_b64_tr_b16 a[210:211], v227 offset:52352
  v_rcp_f32 v148, v105
  v_rcp_f32 v150, v106
  v_mul_f32 v96, v96, v148
  v_mfma_f32_16x16x32_bf16 v[24:27], a[180:183], v[112:115], v[24:27]
  v_mul_f32 v97, v97, v148
  v_mul_f32 v98, v98, v148
  v_mfma_f32_16x16x32_bf16 v[48:51], a[180:183], v[116:119], v[48:51]
  ds_read_b64_tr_b16 a[212:213], v227 offset:48512
  v_mul_f32 v99, v99, v148
  v_mul_f32 v100, v100, v150
  v_mfma_f32_16x16x32_bf16 v[28:31], a[184:187], v[112:115], v[28:31]
  ds_read_b64_tr_b16 a[214:215], v228 offset:52352
  v_mul_f32 v101, v101, v150
  v_mul_f32 v102, v102, v150
  v_mul_f32 v103, v103, v150
  v_mfma_f32_16x16x32_bf16 v[52:55], a[184:187], v[116:119], v[52:55]
  v_cndmask_b32 v149, v150, v148, s[60:61]
  v_cvt_pk_bf16_f32 v124, v96, v97
  v_mfma_f32_16x16x32_bf16 v[32:35], a[188:191], v[112:115], v[32:35]
  v_cvt_pk_bf16_f32 v125, v98, v99
  v_cvt_pk_bf16_f32 v126, v100, v101
  v_mfma_f32_16x16x32_bf16 v[56:59], a[188:191], v[116:119], v[56:59]
  v_cvt_pk_bf16_f32 v127, v102, v103
  v_mul_f32 v143, v104, v149
  s_nop 1
  s_waitcnt lgkmcnt(0)
  v_mfma_f32_16x16x32_bf16 v[12:15], a[192:195], v[120:123], v[12:15]
  ds_read_b64_tr_b16 a[168:169], v229 offset:0
  ds_read_b64_tr_b16 a[170:171], v229 offset:27648
  v_mfma_f32_16x16x32_bf16 v[36:39], a[192:195], v[124:127], v[36:39]
  ds_read_b64_tr_b16 a[172:173], v230 offset:0
  v_cvt_pk_bf16_f32 v112, v128, v129
  v_mfma_f32_16x16x32_bf16 v[16:19], a[196:199], v[120:123], v[16:19]
  ds_read_b64_tr_b16 a[174:175], v230 offset:27648
  v_cvt_pk_bf16_f32 v113, v130, v131
  v_mfma_f32_16x16x32_bf16 v[40:43], a[196:199], v[124:127], v[40:43]
  ds_read_b64_tr_b16 a[176:177], v229 offset:64
  v_cvt_pk_bf16_f32 v114, v132, v133
  v_mfma_f32_16x16x32_bf16 v[20:23], a[200:203], v[120:123], v[20:23]
  ds_read_b64_tr_b16 a[178:179], v229 offset:27712
  v_cvt_pk_bf16_f32 v115, v134, v135
  v_mfma_f32_16x16x32_bf16 v[44:47], a[200:203], v[124:127], v[44:47]
  ds_read_b64_tr_b16 a[180:181], v230 offset:64
  ds_read_b64_tr_b16 a[182:183], v230 offset:27712
  v_mfma_f32_16x16x32_bf16 v[24:27], a[204:207], v[120:123], v[24:27]
  ds_read_b64_tr_b16 a[184:185], v229 offset:128
  v_cvt_pk_bf16_f32 v116, v136, v137
  v_mfma_f32_16x16x32_bf16 v[48:51], a[204:207], v[124:127], v[48:51]
  ds_read_b64_tr_b16 a[186:187], v229 offset:27776
  v_cvt_pk_bf16_f32 v117, v138, v139
  v_mfma_f32_16x16x32_bf16 v[28:31], a[208:211], v[120:123], v[28:31]
  ds_read_b64_tr_b16 a[188:189], v230 offset:128
  v_cvt_pk_bf16_f32 v118, v140, v141
  v_mfma_f32_16x16x32_bf16 v[52:55], a[208:211], v[124:127], v[52:55]
  ds_read_b64_tr_b16 a[190:191], v230 offset:27776
  v_cvt_pk_bf16_f32 v119, v142, v143
  v_mfma_f32_16x16x32_bf16 v[32:35], a[212:215], v[120:123], v[32:35]
  v_mfma_f32_16x16x32_bf16 v[56:59], a[212:215], v[124:127], v[56:59]
  s_nop 1
  s_waitcnt lgkmcnt(0)
  v_mfma_f32_16x16x32_bf16 v[12:15], a[168:171], v[112:115], v[12:15]
  v_mfma_f32_16x16x32_bf16 v[36:39], a[168:171], v[116:119], v[36:39]
  v_mfma_f32_16x16x32_bf16 v[16:19], a[172:175], v[112:115], v[16:19]
  v_mfma_f32_16x16x32_bf16 v[40:43], a[172:175], v[116:119], v[40:43]
  v_mfma_f32_16x16x32_bf16 v[20:23], a[176:179], v[112:115], v[20:23]
  v_mfma_f32_16x16x32_bf16 v[44:47], a[176:179], v[116:119], v[44:47]
  v_mfma_f32_16x16x32_bf16 v[24:27], a[180:183], v[112:115], v[24:27]
  v_mfma_f32_16x16x32_bf16 v[48:51], a[180:183], v[116:119], v[48:51]
  v_mfma_f32_16x16x32_bf16 v[28:31], a[184:187], v[112:115], v[28:31]
  v_mfma_f32_16x16x32_bf16 v[52:55], a[184:187], v[116:119], v[52:55]
  v_mfma_f32_16x16x32_bf16 v[32:35], a[188:191], v[112:115], v[32:35]
  v_mfma_f32_16x16x32_bf16 v[56:59], a[188:191], v[116:119], v[56:59]
  s_nop 1
  s_nop 5
  s_cmp_eq_u32 s33, 0
  s_cbranch_scc0 standalone__linear_attn_block__prompt_kernel_k1
  ds_write_b128 v212, v[36:39] offset:0
  ds_write_b128 v212, v[40:43] offset:1024
  ds_write_b128 v212, v[44:47] offset:2048
  ds_write_b128 v212, v[48:51] offset:3072
  ds_write_b128 v212, v[52:55] offset:4096
  ds_write_b128 v212, v[56:59] offset:5120
  s_waitcnt lgkmcnt(0)
  s_barrier
  ds_read_b128 v[156:159], v213 offset:0
  ds_read_b128 v[160:163], v213 offset:1024
  ds_read_b128 v[164:167], v213 offset:2048
  ds_read_b128 v[168:171], v213 offset:3072
  ds_read_b128 v[172:175], v213 offset:4096
  ds_read_b128 v[176:179], v213 offset:5120
  s_waitcnt lgkmcnt(5)
  v_pk_add_f32 v[12:13], v[12:13], v[156:157]
  v_pk_add_f32 v[14:15], v[14:15], v[158:159]
  v_cvt_pk_bf16_f32 v180, v12, v13
  v_cvt_pk_bf16_f32 v181, v14, v15
  ds_write_b64 v253, v[180:181] offset:0
  s_waitcnt lgkmcnt(5)
  v_pk_add_f32 v[16:17], v[16:17], v[160:161]
  v_pk_add_f32 v[18:19], v[18:19], v[162:163]
  v_cvt_pk_bf16_f32 v182, v16, v17
  v_cvt_pk_bf16_f32 v183, v18, v19
  ds_write_b64 v253, v[182:183] offset:32
  s_waitcnt lgkmcnt(5)
  v_pk_add_f32 v[20:21], v[20:21], v[164:165]
  v_pk_add_f32 v[22:23], v[22:23], v[166:167]
  v_cvt_pk_bf16_f32 v184, v20, v21
  v_cvt_pk_bf16_f32 v185, v22, v23
  ds_write_b64 v253, v[184:185] offset:64
  s_waitcnt lgkmcnt(5)
  v_pk_add_f32 v[24:25], v[24:25], v[168:169]
  v_pk_add_f32 v[26:27], v[26:27], v[170:171]
  v_cvt_pk_bf16_f32 v186, v24, v25
  v_cvt_pk_bf16_f32 v187, v26, v27
  ds_write_b64 v253, v[186:187] offset:96
  s_waitcnt lgkmcnt(5)
  v_pk_add_f32 v[28:29], v[28:29], v[172:173]
  v_pk_add_f32 v[30:31], v[30:31], v[174:175]
  v_cvt_pk_bf16_f32 v188, v28, v29
  v_cvt_pk_bf16_f32 v189, v30, v31
  ds_write_b64 v253, v[188:189] offset:128
  s_waitcnt lgkmcnt(5)
  v_pk_add_f32 v[32:33], v[32:33], v[176:177]
  v_pk_add_f32 v[34:35], v[34:35], v[178:179]
  v_cvt_pk_bf16_f32 v190, v32, v33
  v_cvt_pk_bf16_f32 v191, v34, v35
  ds_write_b64 v253, v[190:191] offset:160
  s_waitcnt lgkmcnt(0)
  ds_read_b128 v[196:199], v214
  ds_read_b128 v[200:203], v215
  ds_read_b128 v[204:207], v216
  s_waitcnt lgkmcnt(2)
  buffer_store_dwordx4 v[196:199], v250, s[84:87], 0 offen sc1
  s_waitcnt lgkmcnt(1)
  buffer_store_dwordx4 v[200:203], v251, s[84:87], 0 offen sc1
  s_waitcnt lgkmcnt(0)
  buffer_store_dwordx4 v[204:207], v252, s[84:87], 0 offen sc1
  s_branch standalone__linear_attn_block__prompt_kernel_fin
standalone__linear_attn_block__prompt_kernel_k1:
  ds_write_b128 v212, v[12:15] offset:0
  ds_write_b128 v212, v[16:19] offset:1024
  ds_write_b128 v212, v[20:23] offset:2048
  ds_write_b128 v212, v[24:27] offset:3072
  ds_write_b128 v212, v[28:31] offset:4096
  ds_write_b128 v212, v[32:35] offset:5120
  s_waitcnt lgkmcnt(0)
  s_barrier
  ds_read_b128 v[156:159], v213 offset:0
  ds_read_b128 v[160:163], v213 offset:1024
  ds_read_b128 v[164:167], v213 offset:2048
  ds_read_b128 v[168:171], v213 offset:3072
  ds_read_b128 v[172:175], v213 offset:4096
  ds_read_b128 v[176:179], v213 offset:5120
  s_waitcnt lgkmcnt(5)
  v_pk_add_f32 v[36:37], v[36:37], v[156:157]
  v_pk_add_f32 v[38:39], v[38:39], v[158:159]
  v_cvt_pk_bf16_f32 v180, v36, v37
  v_cvt_pk_bf16_f32 v181, v38, v39
  ds_write_b64 v253, v[180:181] offset:0
  s_waitcnt lgkmcnt(5)
  v_pk_add_f32 v[40:41], v[40:41], v[160:161]
  v_pk_add_f32 v[42:43], v[42:43], v[162:163]
  v_cvt_pk_bf16_f32 v182, v40, v41
  v_cvt_pk_bf16_f32 v183, v42, v43
  ds_write_b64 v253, v[182:183] offset:32
  s_waitcnt lgkmcnt(5)
  v_pk_add_f32 v[44:45], v[44:45], v[164:165]
  v_pk_add_f32 v[46:47], v[46:47], v[166:167]
  v_cvt_pk_bf16_f32 v184, v44, v45
  v_cvt_pk_bf16_f32 v185, v46, v47
  ds_write_b64 v253, v[184:185] offset:64
  s_waitcnt lgkmcnt(5)
  v_pk_add_f32 v[48:49], v[48:49], v[168:169]
  v_pk_add_f32 v[50:51], v[50:51], v[170:171]
  v_cvt_pk_bf16_f32 v186, v48, v49
  v_cvt_pk_bf16_f32 v187, v50, v51
  ds_write_b64 v253, v[186:187] offset:96
  s_waitcnt lgkmcnt(5)
  v_pk_add_f32 v[52:53], v[52:53], v[172:173]
  v_pk_add_f32 v[54:55], v[54:55], v[174:175]
  v_cvt_pk_bf16_f32 v188, v52, v53
  v_cvt_pk_bf16_f32 v189, v54, v55
  ds_write_b64 v253, v[188:189] offset:128
  s_waitcnt lgkmcnt(5)
  v_pk_add_f32 v[56:57], v[56:57], v[176:177]
  v_pk_add_f32 v[58:59], v[58:59], v[178:179]
  v_cvt_pk_bf16_f32 v190, v56, v57
  v_cvt_pk_bf16_f32 v191, v58, v59
  ds_write_b64 v253, v[190:191] offset:160
  s_waitcnt lgkmcnt(0)
  ds_read_b128 v[196:199], v214
  ds_read_b128 v[200:203], v215
  ds_read_b128 v[204:207], v216
  s_waitcnt lgkmcnt(2)
  buffer_store_dwordx4 v[196:199], v250, s[84:87], 0 offen sc1
  s_waitcnt lgkmcnt(1)
  buffer_store_dwordx4 v[200:203], v251, s[84:87], 0 offen sc1
  s_waitcnt lgkmcnt(0)
  buffer_store_dwordx4 v[204:207], v252, s[84:87], 0 offen sc1
standalone__linear_attn_block__prompt_kernel_fin:
standalone__linear_attn_block__prompt_kernel_end:
  s_endpgm
.section .rodata,"a"
.p2align 6
.amdhsa_kernel standalone__linear_attn_block__prompt_kernel
  .amdhsa_next_free_vgpr 472
  .amdhsa_next_free_sgpr 102
  .amdhsa_accum_offset 256
  .amdhsa_group_segment_fixed_size 0
  .amdhsa_kernarg_size 48
  .amdhsa_user_sgpr_count 2
  .amdhsa_user_sgpr_kernarg_segment_ptr 1
  .amdhsa_system_sgpr_workgroup_id_x 1
.end_amdhsa_kernel
```
